```python
import torch

def _softmax(x, axis=-1):
    return torch.softmax(x, dim=axis)
def _gelu(x):
    return torch.nn.functional.gelu(x, approximate="tanh")
def _silu(x):
    return torch.nn.functional.silu(x)
def _sigmoid(x):
    return torch.sigmoid(x)
def _layernorm(x, axis=-1, eps=1e-5):
    m = x.mean(dim=axis, keepdim=True)
    v = x.var(dim=axis, keepdim=True, unbiased=False)
    return (x - m) / torch.sqrt(v + eps)
def _scatter_add(tgt, idx, src, axis=0):
    return tgt.clone().index_add_(axis, idx, src)
def _segment_sum(src, seg, n):
    out = torch.zeros((n,) + src.shape[1:], dtype=src.dtype)
    return out.index_add_(0, seg, src)
def _pad(x, pw):
    flat = tuple(v for pair in reversed(pw) for v in pair)
    return torch.nn.functional.pad(x, flat)

kernel_name = 'parallel_sum__linear_attn_block__dense_activation_gelu__prompt'

def setup_inputs():

    _w = (lambda a: (lambda t: t.to(torch.bfloat16) if t.is_floating_point() else t)(torch.as_tensor(a)))
    def _A_setup():
        B, S, D = 1, 2048, 512
        return {
            "x": _w((lambda *s: torch.randn(*s, dtype=torch.bfloat16) * 0.05)(B, S, D)),
            "wqkv": _w((lambda *s: torch.randn(*s, dtype=torch.bfloat16) * 0.2)(D, 3 * D)),
            "wo": _w((lambda *s: torch.randn(*s, dtype=torch.bfloat16) * 0.05)(D, D)),
        }
    _A_in = _A_setup()

    def _B_setup():
        B, S, D, F = 1, 2048, 512, 1792
        return {
            "x": _w((lambda *s: torch.randn(*s, dtype=torch.bfloat16) * 0.05)(B, S, D)),
            "w1": _w((lambda *s: torch.randn(*s, dtype=torch.bfloat16) * 0.8)(D, F) * (D ** -0.5)),
            "b1": _w((lambda *s: torch.randn(*s, dtype=torch.bfloat16) * 12.8)(F) * 0.01),
            "w2": _w((lambda *s: torch.randn(*s, dtype=torch.bfloat16) * 0.8)(F, D) * (F ** -0.5)),
            "b2": _w((lambda *s: torch.randn(*s, dtype=torch.bfloat16) * 12.8)(D) * 0.01),
        }
    _B_in = _B_setup()

    return {
        "A_x": _A_in["x"],
        "A_wqkv": _A_in["wqkv"],
        "A_wo": _A_in["wo"],
        "B_x": _B_in["x"],
        "B_w1": _B_in["w1"],
        "B_b1": _B_in["b1"],
        "B_w2": _B_in["w2"],
        "B_b2": _B_in["b2"],
    }

def reference(A_x, A_wqkv, A_wo, B_x, B_w1, B_b1, B_w2, B_b2):
    def _A_ref(x, wqkv, wo):
        B, S, D = x.shape
        H = 32; Dh = D // H
        qkv = (lambda x, *d: x.permute(*d))((x @ wqkv).reshape(B, S, 3, H, Dh), 2, 0, 3, 1, 4)
        q, k, v = qkv[0], qkv[1], qkv[2]
        phi = lambda t: torch.where(t > 0, t + 1, torch.exp(t)) + 1e-6
        pq, pk = phi(q), phi(k)
        kv = torch.einsum("bhsd,bhse->bhde", pk, v)
        z = torch.einsum("bhsd->bhd", pk)
        num = torch.einsum("bhqd,bhde->bhqe", pq, kv)
        den = torch.einsum("bhqd,bhd->bhq", pq, z)[..., None] + 1e-6
        o = num / den
        return (lambda x, *d: x.permute(*d))(o, 0, 2, 1, 3).reshape(B, S, D) @ wo

    def _B_ref(x, w1, b1, w2, b2):
        h = torch.einsum("bsd,df->bsf", x, w1) + b1
        h = _gelu(h)
        return torch.einsum("bsf,fd->bsd", h, w2) + b2

    x = A_x
    xn = _layernorm(x, axis=-1)
    return x + _A_ref(xn, A_wqkv, A_wo) + _B_ref(xn, B_w1, B_b1, B_w2, B_b2)
```

```asm
; @launch grid=(256,1,1) block=(512,1,1) lds=163840
.amdgcn_target "amdgcn-amd-amdhsa--gfx950"
.text
.globl parallel_sum__linear_attn_block__dense_activation_gelu__prompt_kernel
.p2align 8
.type parallel_sum__linear_attn_block__dense_activation_gelu__prompt_kernel,@function
parallel_sum__linear_attn_block__dense_activation_gelu__prompt_kernel:

    s_cmp_ge_u32 s2, 256
    s_cbranch_scc1 .Lp1_end
    s_load_dwordx16 s[4:19], s[0:1], 0
    s_load_dwordx4 s[20:23], s[0:1], 64
    s_load_dwordx2 s[24:25], s[0:1], 80
    s_setprio 3
    v_lshrrev_b32 v1, 6, v0
    v_and_b32 v0, 63, v0
    v_readfirstlane_b32 s3, v1
    s_and_b32 s56, s2, 7
    s_lshr_b32 s57, s2, 3
    s_and_b32 s58, s56, 1
    s_lshl_b32 s58, s58, 3
    s_and_b32 s59, s57, 7
    s_add_u32 s58, s58, s59
    s_lshr_b32 s56, s56, 1
    s_lshl_b32 s56, s56, 2
    s_lshr_b32 s57, s57, 3
    s_add_u32 s56, s56, s57
    s_and_b32 s57, s56, 1
    s_lshr_b32 s59, s56, 1
    s_add_u32 s71, s56, s58
    s_and_b32 s71, s71, 1
    s_bfe_u32 s72, s58, 0x20001
    s_and_b32 s60, s3, 3
    s_lshr_b32 s56, s3, 2
    s_lshl_b32 s62, s3, 10
    s_lshl_b32 s63, s58, 17
    v_lshrrev_b32 v124, 3, v0
    s_lshl_b32 s64, s3, 3
    v_add_u32 v124, s64, v124
    v_bfe_u32 v125, v124, 1, 3
    v_and_b32 v126, 7, v0
    v_xor_b32 v125, v125, v126
    v_lshlrev_b32 v124, 10, v124
    v_lshl_add_u32 v1, v125, 4, v124
    s_waitcnt lgkmcnt(0)
    s_mov_b32 s28, s4
    s_and_b32 s29, s5, 0xffff
    s_mov_b32 s30, 2097152
    s_mov_b32 s31, 0x00020000
    s_cmp_eq_u32 s57, 0
    s_cbranch_scc1 .Lp1_A
.Lp1_B:
    v_lshrrev_b32 v124, 3, v0
    s_lshl_b32 s65, s3, 3
    v_add_u32 v124, s65, v124
    v_mul_u32_u24 v124, 3584, v124
    v_and_b32 v125, 7, v0
    v_lshrrev_b32 v126, 2, v0
    v_and_b32 v126, 4, v126
    v_xor_b32 v125, v125, v126
    v_lshl_add_u32 v2, v125, 4, v124
    s_mul_i32 s64, s59, 448
    s_and_b32 s66, s59, 1
    s_lshl_b32 s67, s66, 6
    s_xor_b32 s66, s66, 1
    s_mul_i32 s66, s66, 384
    s_add_u32 s61, s64, s66
    s_add_u32 s64, s64, s67
    s_mov_b32 s32, s12
    s_and_b32 s33, s13, 0xffff
    s_mov_b32 s34, 1835008
    s_mov_b32 s35, 0x00020000
    s_lshl_b32 s70, s71, 9
    s_add_u32 s40, s63, s70
    s_sub_u32 s41, s63, s70
    s_mul_i32 s73, s71, 917504
    s_add_u32 s42, s64, s73
    s_sub_u32 s43, s64, s73
    s_add_u32 m0, s62, 98304
    s_add_u32 s70, s40, 0
    buffer_load_dwordx4 v1, s[28:31], s70 offen lds
    s_add_u32 m0, s62, 106496
    s_add_u32 s70, s40, 65536
    buffer_load_dwordx4 v1, s[28:31], s70 offen lds
    s_add_u32 m0, s62, 0
    s_add_u32 s70, s42, 0
    buffer_load_dwordx4 v2, s[32:35], s70 offen lds
    s_setprio 2
    s_add_u32 m0, s62, 114688
    s_add_u32 s70, s40, 128
    buffer_load_dwordx4 v1, s[28:31], s70 offen lds
    s_add_u32 m0, s62, 122880
    s_add_u32 s70, s40, 65664
    buffer_load_dwordx4 v1, s[28:31], s70 offen lds
    s_add_u32 m0, s62, 8192
    s_add_u32 s70, s42, 229376
    buffer_load_dwordx4 v2, s[32:35], s70 offen lds
    s_xor_b32 s74, s73, 917504
    s_add_u32 s70, s72, 0
    s_and_b32 s70, s70, 3
    s_lshl_b32 s44, s70, 13
    s_add_u32 s44, s44, s62
    s_mul_i32 s48, s70, 229376
    s_add_u32 s48, s48, s64
    s_add_u32 s70, s72, 1
    s_and_b32 s70, s70, 3
    s_lshl_b32 s45, s70, 13
    s_add_u32 s45, s45, s62
    s_mul_i32 s49, s70, 229376
    s_add_u32 s49, s49, s64
    s_add_u32 s70, s72, 2
    s_and_b32 s70, s70, 3
    s_lshl_b32 s46, s70, 13
    s_add_u32 s46, s46, s62
    s_mul_i32 s50, s70, 229376
    s_add_u32 s50, s50, s64
    s_add_u32 s70, s72, 3
    s_and_b32 s70, s70, 3
    s_lshl_b32 s47, s70, 13
    s_add_u32 s47, s47, s62
    s_mul_i32 s51, s70, 229376
    s_add_u32 s51, s51, s64
    s_mov_b64 s[10:11], s[14:15]
    v_lshrrev_b32 v124, 2, v0
    s_lshl_b32 s65, s3, 4
    v_add_u32 v124, s65, v124
    v_mul_u32_u24 v124, 3584, v124
    v_and_b32 v125, 3, v0
    v_lshl_add_u32 v3, v125, 4, v124
    v_and_b32 v124, 31, v0
    v_bfe_u32 v125, v0, 1, 3
    v_lshrrev_b32 v126, 5, v0
    v_xor_b32 v125, v125, v126
    v_lshlrev_b32 v124, 7, v124
    v_lshl_add_u32 v124, v125, 4, v124
    s_lshl_b32 s65, s60, 12
    s_add_u32 s65, s65, 98304
    v_add_u32 v4, s65, v124
    s_lshl_b32 s65, s60, 5
    v_xor_b32 v4, s65, v4
    v_xor_b32 v5, 32, v4
    v_xor_b32 v6, 64, v4
    v_xor_b32 v7, 96, v4
    v_lshrrev_b32 v124, 5, v0
    v_lshlrev_b32 v124, 3, v124
    v_bfe_u32 v125, v0, 2, 2
    v_add_u32 v124, v124, v125
    v_bfe_u32 v125, v0, 4, 1
    v_lshlrev_b32 v125, 5, v125
    v_and_b32 v126, 3, v0
    v_lshl_add_u32 v125, v126, 3, v125
    v_bfe_u32 v126, v0, 3, 1
    v_xor_b32 v126, s56, v126
    v_lshl_add_u32 v126, v126, 6, v125
    v_lshl_add_u32 v8, v124, 7, v126
    s_lshl_b32 s65, s60, 11
    v_add_u32 v8, s65, v8
    v_xor_b32 v9, 2048, v8
    v_xor_b32 v10, 4096, v8
    v_xor_b32 v11, 6144, v8
    v_lshl_add_u32 v12, v124, 6, v125
    s_lshl_b32 s65, s60, 10
    s_add_u32 s65, s65, 0x10000
    v_add_u32 v12, s65, v12
    v_and_b32 v124, 15, v0
    v_bfe_u32 v125, v0, 1, 3
    v_lshrrev_b32 v126, 4, v0
    v_xor_b32 v125, v125, v126
    v_lshlrev_b32 v124, 7, v124
    v_lshl_add_u32 v124, v125, 4, v124
    s_lshl_b32 s65, s3, 11
    s_add_u32 s65, s65, 98304
    v_add_u32 v14, s65, v124
    v_xor_b32 v15, 64, v14
    v_lshrrev_b32 v124, 4, v0
    v_xor_b32 v124, v124, v0
    v_and_b32 v124, 1, v124
    v_cmp_eq_u32 vcc, 0, v124
    v_mov_b32 v22, 0x3f803f80
    v_mov_b32 v36, 0x3f803f80
    v_mov_b32 v37, 0x3f803f80
    v_mov_b32 v38, 0x3f803f80
    v_mov_b32 v39, 0x3f803f80
    v_cndmask_b32 v16, 0, v22, vcc
    v_cndmask_b32 v17, 0, v22, vcc
    v_cndmask_b32 v18, 0, v22, vcc
    v_cndmask_b32 v19, 0, v22, vcc
    v_lshlrev_b32 v23, 4, v0
    s_lshl_b32 s65, s60, 2
    s_add_u32 s65, s65, 159744
    v_mov_b32 v124, s65
    v_mov_b32 v125, 0
    ds_write_b32 v124, v125
    s_mov_b32 s36, s24
    s_and_b32 s37, s25, 0xffff
    s_mov_b32 s38, 9437184
    s_mov_b32 s39, 0x00020000
    s_lshl_b32 s68, s58, 2
    s_add_u32 s68, s68, s60
    s_mul_i32 s68, s68, 147456
    s_lshl_b32 s65, s61, 5
    s_add_u32 s69, s68, s65
    s_lshl_b32 s65, s64, 5
    s_add_u32 s68, s68, s65
    s_lshl_b32 s65, s56, 11
    s_add_u32 s68, s68, s65
    s_mov_b32 s12, s16
    s_and_b32 s13, s17, 0xffff
    s_mov_b32 s14, 1835008
    s_mov_b32 s15, 0x00020000
    s_mov_b32 s4, s8
    s_and_b32 s5, s9, 0xffff
    s_mov_b32 s6, 524288
    s_mov_b32 s7, 0x00020000
    v_and_b32 v13, 7, v0
    v_lshlrev_b32 v13, 7, v13
    s_lshr_b32 s76, s2, 3
    s_lshl_b32 s76, s76, 10
    v_add_u32 v13, s76, v13
    s_and_b32 s77, s3, 1
    s_lshl_b32 s77, s77, 15
    s_mul_i32 s27, s3, 229376
    s_setprio 1
    s_add_u32 m0, s62, 131072
    s_add_u32 s70, s40, 256
    buffer_load_dwordx4 v1, s[28:31], s70 offen lds
    s_add_u32 m0, s62, 139264
    s_add_u32 s70, s40, 65792
    buffer_load_dwordx4 v1, s[28:31], s70 offen lds
    s_add_u32 m0, s62, 16384
    s_add_u32 s70, s42, 458752
    buffer_load_dwordx4 v2, s[32:35], s70 offen lds
    s_setprio 3
    s_waitcnt vmcnt(6)
    s_barrier
    ds_read_b128 v[128:131], v4 offset:0
    ds_read_b64_tr_b16 v[60:61], v8 offset:0
    ds_read_b64_tr_b16 v[62:63], v8 offset:512
    ds_read_b128 v[132:135], v5 offset:0
    ds_read_b64_tr_b16 v[64:65], v9 offset:0
    ds_read_b64_tr_b16 v[66:67], v9 offset:512
    ds_read_b128 v[136:139], v6 offset:0
    ds_read_b64_tr_b16 v[68:69], v10 offset:0
    ds_read_b64_tr_b16 v[70:71], v10 offset:512
    ds_read_b128 v[140:143], v7 offset:0
    ds_read_b64_tr_b16 v[72:73], v11 offset:0
    ds_read_b64_tr_b16 v[74:75], v11 offset:512
    ds_read_b128 v[100:103], v14 offset:0
    ds_read_b128 v[104:107], v15 offset:0
    s_waitcnt vmcnt(3) lgkmcnt(0)
    s_barrier
    v_mfma_f32_32x32x16_bf16 v[44:59], v[60:63], v[128:131], 0
    ds_read_b128 v[144:147], v4 offset:16384
    ds_read_b64_tr_b16 v[80:81], v8 offset:8192
    v_mfma_f32_16x16x32_bf16 v[28:31], v[100:103], v[100:103], 0
    ds_read_b64_tr_b16 v[82:83], v8 offset:8704
    ds_read_b128 v[148:151], v5 offset:16384
    s_add_u32 m0, s62, 65536
    s_add_u32 s70, s40, 384
    buffer_load_dwordx4 v1, s[28:31], s70 offen lds
    v_mfma_f32_32x32x16_bf16 v[44:59], v[64:67], v[132:135], v[44:59]
    ds_read_b64_tr_b16 v[84:85], v9 offset:8192
    ds_read_b64_tr_b16 v[86:87], v9 offset:8704
    v_mfma_f32_16x16x32_bf16 v[32:35], v[100:103], v[36:39], 0
    ds_read_b128 v[152:155], v6 offset:16384
    s_add_u32 m0, s62, 73728
    s_add_u32 s70, s40, 65920
    buffer_load_dwordx4 v1, s[28:31], s70 offen lds
    ds_read_b64_tr_b16 v[88:89], v10 offset:8192
    v_mfma_f32_16x16x32_bf16 v[28:31], v[104:107], v[104:107], v[28:31]
    ds_read_b64_tr_b16 v[90:91], v10 offset:8704
    ds_read_b128 v[156:159], v7 offset:16384
    v_mfma_f32_32x32x16_bf16 v[44:59], v[68:71], v[136:139], v[44:59]
    ds_read_b64_tr_b16 v[92:93], v11 offset:8192
    s_add_u32 m0, s62, 24576
    s_add_u32 s70, s42, 688128
    buffer_load_dwordx4 v2, s[32:35], s70 offen lds
    ds_read_b64_tr_b16 v[94:95], v11 offset:8704
    v_mfma_f32_16x16x32_bf16 v[32:35], v[104:107], v[36:39], v[32:35]
    ds_read_b128 v[108:111], v14 offset:16384
    ds_read_b128 v[112:115], v15 offset:16384
    s_add_u32 m0, s62, 81920
    s_add_u32 s70, s41, 512
    buffer_load_dwordx4 v1, s[28:31], s70 offen lds
    v_mfma_f32_32x32x16_bf16 v[44:59], v[72:75], v[140:143], v[44:59]
    v_mfma_f32_16x16x32_bf16 v[24:27], v[60:63], v[16:19], 0
    s_waitcnt vmcnt(4) lgkmcnt(0)
    s_barrier
    v_mfma_f32_32x32x16_bf16 v[44:59], v[80:83], v[144:147], v[44:59]
    ds_read_b128 v[160:163], v4 offset:32768
    ds_read_b64_tr_b16 v[60:61], v8 offset:16384
    v_mfma_f32_16x16x32_bf16 v[28:31], v[108:111], v[108:111], v[28:31]
    ds_read_b64_tr_b16 v[62:63], v8 offset:16896
    ds_read_b128 v[164:167], v5 offset:32768
    s_add_u32 m0, s62, 90112
    s_add_u32 s70, s41, 66048
    buffer_load_dwordx4 v1, s[28:31], s70 offen lds
    v_mfma_f32_32x32x16_bf16 v[44:59], v[84:87], v[148:151], v[44:59]
    ds_read_b64_tr_b16 v[64:65], v9 offset:16384
    ds_read_b64_tr_b16 v[66:67], v9 offset:16896
    v_mfma_f32_16x16x32_bf16 v[32:35], v[108:111], v[36:39], v[32:35]
    ds_read_b128 v[168:171], v6 offset:32768
    s_add_u32 m0, s62, 32768
    s_add_u32 s70, s43, 917504
    buffer_load_dwordx4 v2, s[32:35], s70 offen lds
    ds_read_b64_tr_b16 v[68:69], v10 offset:16384
    v_mfma_f32_16x16x32_bf16 v[28:31], v[112:115], v[112:115], v[28:31]
    ds_read_b64_tr_b16 v[70:71], v10 offset:16896
    ds_read_b128 v[172:175], v7 offset:32768
    v_mfma_f32_32x32x16_bf16 v[44:59], v[88:91], v[152:155], v[44:59]
    ds_read_b64_tr_b16 v[72:73], v11 offset:16384
    s_add_u32 m0, s62, 98304
    s_add_u32 s70, s41, 640
    buffer_load_dwordx4 v1, s[28:31], s70 offen lds
    ds_read_b64_tr_b16 v[74:75], v11 offset:16896
    v_mfma_f32_16x16x32_bf16 v[32:35], v[112:115], v[36:39], v[32:35]
    ds_read_b128 v[100:103], v14 offset:32768
    ds_read_b128 v[104:107], v15 offset:32768
    s_add_u32 m0, s62, 106496
    s_add_u32 s70, s41, 66176
    buffer_load_dwordx4 v1, s[28:31], s70 offen lds
    v_mfma_f32_32x32x16_bf16 v[44:59], v[92:95], v[156:159], v[44:59]
    v_mfma_f32_16x16x32_bf16 v[24:27], v[80:83], v[16:19], v[24:27]
    s_waitcnt vmcnt(5) lgkmcnt(0)
    s_barrier
    v_mfma_f32_32x32x16_bf16 v[44:59], v[60:63], v[160:163], v[44:59]
    v_subrev_u32 v4, 0x8000, v4
    v_subrev_u32 v5, 0x8000, v5
    v_subrev_u32 v6, 0x8000, v6
    v_mfma_f32_16x16x32_bf16 v[28:31], v[100:103], v[100:103], v[28:31]
    v_subrev_u32 v7, 0x8000, v7
    v_subrev_u32 v14, 0x8000, v14
    s_add_u32 m0, s62, 40960
    s_add_u32 s70, s43, 1146880
    buffer_load_dwordx4 v2, s[32:35], s70 offen lds
    v_mfma_f32_32x32x16_bf16 v[44:59], v[64:67], v[164:167], v[44:59]
    v_subrev_u32 v15, 0x8000, v15
    ds_read_b128 v[176:179], v4 offset:0
    ds_read_b64_tr_b16 v[80:81], v8 offset:24576
    ds_read_b64_tr_b16 v[82:83], v8 offset:25088
    v_mfma_f32_16x16x32_bf16 v[32:35], v[100:103], v[36:39], v[32:35]
    ds_read_b128 v[180:183], v5 offset:0
    s_add_u32 m0, s62, 114688
    s_add_u32 s70, s41, 768
    buffer_load_dwordx4 v1, s[28:31], s70 offen lds
    ds_read_b64_tr_b16 v[84:85], v9 offset:24576
    v_mfma_f32_16x16x32_bf16 v[28:31], v[104:107], v[104:107], v[28:31]
    ds_read_b64_tr_b16 v[86:87], v9 offset:25088
    ds_read_b128 v[184:187], v6 offset:0
    ds_read_b64_tr_b16 v[88:89], v10 offset:24576
    ds_read_b64_tr_b16 v[90:91], v10 offset:25088
    v_mfma_f32_32x32x16_bf16 v[44:59], v[68:71], v[168:171], v[44:59]
    s_add_u32 m0, s62, 122880
    s_add_u32 s70, s41, 66304
    buffer_load_dwordx4 v1, s[28:31], s70 offen lds
    ds_read_b128 v[188:191], v7 offset:0
    ds_read_b64_tr_b16 v[92:93], v11 offset:24576
    v_mfma_f32_16x16x32_bf16 v[32:35], v[104:107], v[36:39], v[32:35]
    ds_read_b64_tr_b16 v[94:95], v11 offset:25088
    ds_read_b128 v[108:111], v14 offset:0
    ds_read_b128 v[112:115], v15 offset:0
    s_add_u32 m0, s62, 49152
    s_add_u32 s70, s43, 1376256
    buffer_load_dwordx4 v2, s[32:35], s70 offen lds
    v_mfma_f32_32x32x16_bf16 v[44:59], v[72:75], v[172:175], v[44:59]
    v_mfma_f32_16x16x32_bf16 v[24:27], v[60:63], v[16:19], v[24:27]
    s_waitcnt vmcnt(6) lgkmcnt(0)
    s_barrier
    v_mfma_f32_32x32x16_bf16 v[44:59], v[80:83], v[176:179], v[44:59]
    ds_read_b128 v[192:195], v4 offset:16384
    ds_read_b64_tr_b16 v[60:61], v8 offset:32768
    v_mfma_f32_16x16x32_bf16 v[28:31], v[108:111], v[108:111], v[28:31]
    ds_read_b64_tr_b16 v[62:63], v8 offset:33280
    ds_read_b128 v[196:199], v5 offset:16384
    s_add_u32 m0, s62, 131072
    s_add_u32 s70, s41, 896
    buffer_load_dwordx4 v1, s[28:31], s70 offen lds
    v_mfma_f32_32x32x16_bf16 v[44:59], v[84:87], v[180:183], v[44:59]
    ds_read_b64_tr_b16 v[64:65], v9 offset:32768
    ds_read_b64_tr_b16 v[66:67], v9 offset:33280
    v_mfma_f32_16x16x32_bf16 v[32:35], v[108:111], v[36:39], v[32:35]
    ds_read_b128 v[200:203], v6 offset:16384
    s_add_u32 m0, s62, 139264
    s_add_u32 s70, s41, 66432
    buffer_load_dwordx4 v1, s[28:31], s70 offen lds
    ds_read_b64_tr_b16 v[68:69], v10 offset:32768
    v_mfma_f32_16x16x32_bf16 v[28:31], v[112:115], v[112:115], v[28:31]
    ds_read_b64_tr_b16 v[70:71], v10 offset:33280
    ds_read_b128 v[204:207], v7 offset:16384
    v_mfma_f32_32x32x16_bf16 v[44:59], v[88:91], v[184:187], v[44:59]
    ds_read_b64_tr_b16 v[72:73], v11 offset:32768
    s_add_u32 m0, s62, 57344
    s_add_u32 s70, s43, 1605632
    buffer_load_dwordx4 v2, s[32:35], s70 offen lds
    ds_read_b64_tr_b16 v[74:75], v11 offset:33280
    v_mfma_f32_16x16x32_bf16 v[32:35], v[112:115], v[36:39], v[32:35]
    ds_read_b128 v[100:103], v14 offset:16384
    ds_read_b128 v[104:107], v15 offset:16384
    s_add_u32 m0, s44, 0
    s_add_u32 s70, s48, s73
    s_add_u32 s70, s70, 256
    buffer_load_dwordx4 v2, s[32:35], s70 offen lds
    v_mfma_f32_32x32x16_bf16 v[44:59], v[92:95], v[188:191], v[44:59]
    v_mfma_f32_16x16x32_bf16 v[24:27], v[80:83], v[16:19], v[24:27]
    s_waitcnt vmcnt(7) lgkmcnt(0)
    s_barrier
    v_mfma_f32_32x32x16_bf16 v[44:59], v[60:63], v[192:195], v[44:59]
    v_add_u32 v4, 0x8000, v4
    v_add_u32 v5, 0x8000, v5
    v_add_u32 v6, 0x8000, v6
    v_mfma_f32_16x16x32_bf16 v[28:31], v[100:103], v[100:103], v[28:31]
    v_add_u32 v7, 0x8000, v7
    v_add_u32 v14, 0x8000, v14
    s_add_u32 m0, s44, 65536
    s_add_u32 s70, s48, s73
    s_add_u32 s70, s70, 128
    buffer_load_dwordx4 v2, s[32:35], s70 offen lds
    v_mfma_f32_32x32x16_bf16 v[44:59], v[64:67], v[196:199], v[44:59]
    v_add_u32 v15, 0x8000, v15
    ds_read_b128 v[208:211], v4 offset:0
    ds_read_b64_tr_b16 v[80:81], v8 offset:40960
    ds_read_b64_tr_b16 v[82:83], v8 offset:41472
    v_mfma_f32_16x16x32_bf16 v[32:35], v[100:103], v[36:39], v[32:35]
    ds_read_b128 v[212:215], v5 offset:0
    s_add_u32 m0, s45, 65536
    s_add_u32 s70, s49, s73
    s_add_u32 s70, s70, 128
    buffer_load_dwordx4 v2, s[32:35], s70 offen lds
    ds_read_b64_tr_b16 v[84:85], v9 offset:40960
    v_mfma_f32_16x16x32_bf16 v[28:31], v[104:107], v[104:107], v[28:31]
    ds_read_b64_tr_b16 v[86:87], v9 offset:41472
    ds_read_b128 v[216:219], v6 offset:0
    ds_read_b64_tr_b16 v[88:89], v10 offset:40960
    ds_read_b64_tr_b16 v[90:91], v10 offset:41472
    v_mfma_f32_32x32x16_bf16 v[44:59], v[68:71], v[200:203], v[44:59]
    s_add_u32 m0, s46, 65536
    s_add_u32 s70, s50, s73
    s_add_u32 s70, s70, 128
    buffer_load_dwordx4 v2, s[32:35], s70 offen lds
    ds_read_b128 v[220:223], v7 offset:0
    ds_read_b64_tr_b16 v[92:93], v11 offset:40960
    v_mfma_f32_16x16x32_bf16 v[32:35], v[104:107], v[36:39], v[32:35]
    ds_read_b64_tr_b16 v[94:95], v11 offset:41472
    ds_read_b128 v[108:111], v14 offset:0
    ds_read_b128 v[112:115], v15 offset:0
    s_add_u32 m0, s47, 65536
    s_add_u32 s70, s51, s73
    s_add_u32 s70, s70, 128
    buffer_load_dwordx4 v2, s[32:35], s70 offen lds
    v_mfma_f32_32x32x16_bf16 v[44:59], v[72:75], v[204:207], v[44:59]
    v_mfma_f32_16x16x32_bf16 v[24:27], v[60:63], v[16:19], v[24:27]
    s_waitcnt vmcnt(8) lgkmcnt(0)
    s_barrier
    v_mfma_f32_32x32x16_bf16 v[44:59], v[80:83], v[208:211], v[44:59]
    ds_read_b128 v[224:227], v4 offset:16384
    ds_read_b64_tr_b16 v[60:61], v8 offset:49152
    v_mfma_f32_16x16x32_bf16 v[28:31], v[108:111], v[108:111], v[28:31]
    ds_read_b64_tr_b16 v[62:63], v8 offset:49664
    ds_read_b128 v[228:231], v5 offset:16384
    s_add_u32 m0, s45, 0
    s_add_u32 s70, s49, s73
    s_add_u32 s70, s70, 256
    buffer_load_dwordx4 v2, s[32:35], s70 offen lds
    v_mfma_f32_32x32x16_bf16 v[44:59], v[84:87], v[212:215], v[44:59]
    ds_read_b64_tr_b16 v[64:65], v9 offset:49152
    ds_read_b64_tr_b16 v[66:67], v9 offset:49664
    v_mfma_f32_16x16x32_bf16 v[32:35], v[108:111], v[36:39], v[32:35]
    ds_read_b128 v[232:235], v6 offset:16384
    s_add_u32 m0, s46, 0
    s_add_u32 s70, s50, s73
    s_add_u32 s70, s70, 256
    buffer_load_dwordx4 v2, s[32:35], s70 offen lds
    ds_read_b64_tr_b16 v[68:69], v10 offset:49152
    v_mfma_f32_16x16x32_bf16 v[28:31], v[112:115], v[112:115], v[28:31]
    ds_read_b64_tr_b16 v[70:71], v10 offset:49664
    ds_read_b128 v[236:239], v7 offset:16384
    v_mfma_f32_32x32x16_bf16 v[44:59], v[88:91], v[216:219], v[44:59]
    ds_read_b64_tr_b16 v[72:73], v11 offset:49152
    s_add_u32 m0, s47, 0
    s_add_u32 s70, s51, s73
    s_add_u32 s70, s70, 256
    buffer_load_dwordx4 v2, s[32:35], s70 offen lds
    ds_read_b64_tr_b16 v[74:75], v11 offset:49664
    v_mfma_f32_16x16x32_bf16 v[32:35], v[112:115], v[36:39], v[32:35]
    ds_read_b128 v[100:103], v14 offset:16384
    ds_read_b128 v[104:107], v15 offset:16384
    s_mov_b32 s52, s10
    s_and_b32 s53, s11, 0xffff
    s_mov_b32 s54, 3584
    s_mov_b32 s55, 0x00020000
    v_and_b32 v124, 31, v0
    v_lshlrev_b32 v124, 1, v124
    s_lshl_b32 s65, s56, 6
    s_add_u32 s65, s65, s64
    buffer_load_ushort v40, v124, s[52:55], s65 offen offset:0
    buffer_load_ushort v41, v124, s[52:55], s65 offen offset:128
    buffer_load_ushort v42, v124, s[52:55], s65 offen offset:256
    buffer_load_ushort v43, v124, s[52:55], s61 offen
    v_mfma_f32_32x32x16_bf16 v[44:59], v[92:95], v[220:223], v[44:59]
    v_mfma_f32_16x16x32_bf16 v[24:27], v[80:83], v[16:19], v[24:27]
    s_waitcnt vmcnt(12) lgkmcnt(0)
    s_barrier
    v_mfma_f32_32x32x16_bf16 v[44:59], v[60:63], v[224:227], v[44:59]
    ds_read_b128 v[240:243], v4 offset:32768
    ds_read_b64_tr_b16 v[80:81], v8 offset:57344
    v_mfma_f32_16x16x32_bf16 v[28:31], v[100:103], v[100:103], v[28:31]
    ds_read_b64_tr_b16 v[82:83], v8 offset:57856
    ds_read_b128 v[244:247], v5 offset:32768
    s_add_u32 m0, s44, 98304
    s_add_u32 s70, s48, s74
    s_add_u32 s70, s70, 128
    buffer_load_dwordx4 v2, s[32:35], s70 offen lds
    v_mfma_f32_32x32x16_bf16 v[44:59], v[64:67], v[228:231], v[44:59]
    ds_read_b64_tr_b16 v[84:85], v9 offset:57344
    ds_read_b64_tr_b16 v[86:87], v9 offset:57856
    v_mfma_f32_16x16x32_bf16 v[32:35], v[100:103], v[36:39], v[32:35]
    ds_read_b128 v[248:251], v6 offset:32768
    s_add_u32 m0, s45, 98304
    s_add_u32 s70, s49, s74
    s_add_u32 s70, s70, 128
    buffer_load_dwordx4 v2, s[32:35], s70 offen lds
    ds_read_b64_tr_b16 v[88:89], v10 offset:57344
    v_mfma_f32_16x16x32_bf16 v[28:31], v[104:107], v[104:107], v[28:31]
    ds_read_b64_tr_b16 v[90:91], v10 offset:57856
    ds_read_b128 v[252:255], v7 offset:32768
    v_mfma_f32_32x32x16_bf16 v[44:59], v[68:71], v[232:235], v[44:59]
    ds_read_b64_tr_b16 v[92:93], v11 offset:57344
    s_add_u32 m0, s46, 98304
    s_add_u32 s70, s50, s74
    s_add_u32 s70, s70, 128
    buffer_load_dwordx4 v2, s[32:35], s70 offen lds
    ds_read_b64_tr_b16 v[94:95], v11 offset:57856
    v_mfma_f32_16x16x32_bf16 v[32:35], v[104:107], v[36:39], v[32:35]
    ds_read_b128 v[108:111], v14 offset:32768
    ds_read_b128 v[112:115], v15 offset:32768
    s_add_u32 m0, s47, 98304
    s_add_u32 s70, s51, s74
    s_add_u32 s70, s70, 128
    buffer_load_dwordx4 v2, s[32:35], s70 offen lds
    v_mfma_f32_32x32x16_bf16 v[44:59], v[72:75], v[236:239], v[44:59]
    v_mfma_f32_16x16x32_bf16 v[24:27], v[60:63], v[16:19], v[24:27]
    s_waitcnt lgkmcnt(0)
    s_barrier
    v_mfma_f32_32x32x16_bf16 v[44:59], v[80:83], v[240:243], v[44:59]
    v_mfma_f32_16x16x32_bf16 v[28:31], v[108:111], v[108:111], v[28:31]
    s_add_u32 m0, s44, 32768
    s_add_u32 s70, s48, s74
    s_add_u32 s70, s70, 256
    buffer_load_dwordx4 v2, s[32:35], s70 offen lds
    v_mfma_f32_32x32x16_bf16 v[44:59], v[84:87], v[244:247], v[44:59]
    v_mfma_f32_16x16x32_bf16 v[32:35], v[108:111], v[36:39], v[32:35]
    s_add_u32 m0, s45, 32768
    s_add_u32 s70, s49, s74
    s_add_u32 s70, s70, 256
    buffer_load_dwordx4 v2, s[32:35], s70 offen lds
    v_mfma_f32_16x16x32_bf16 v[28:31], v[112:115], v[112:115], v[28:31]
    v_mfma_f32_32x32x16_bf16 v[44:59], v[88:91], v[248:251], v[44:59]
    s_add_u32 m0, s46, 32768
    s_add_u32 s70, s50, s74
    s_add_u32 s70, s70, 256
    buffer_load_dwordx4 v2, s[32:35], s70 offen lds
    v_mfma_f32_16x16x32_bf16 v[32:35], v[112:115], v[36:39], v[32:35]
    s_add_u32 m0, s47, 32768
    s_add_u32 s70, s51, s74
    s_add_u32 s70, s70, 256
    buffer_load_dwordx4 v2, s[32:35], s70 offen lds
    v_mfma_f32_32x32x16_bf16 v[44:59], v[92:95], v[252:255], v[44:59]
    v_mfma_f32_16x16x32_bf16 v[24:27], v[80:83], v[16:19], v[24:27]
    v_and_b32 v126, 15, v0
    v_lshlrev_b32 v126, 6, v126
    v_lshrrev_b32 v127, 4, v0
    v_lshl_add_u32 v126, v127, 4, v126
    s_add_u32 s65, s62, 147456
    v_add_u32 v126, s65, v126
    s_lshl_b32 s65, s3, 6
    s_add_u32 s65, s65, 155648
    v_lshl_add_u32 v127, v127, 4, s65
    ds_write_b128 v126, v[28:31]
    ds_write_b128 v127, v[32:35]
    v_and_b32 v124, 1, v0
    v_lshlrev_b32 v124, 6, v124
    v_lshrrev_b32 v125, 4, v0
    v_lshl_add_u32 v124, v125, 4, v124
    s_lshl_b32 s65, s3, 7
    s_add_u32 s65, s65, 156160
    v_add_u32 v124, s65, v124
    s_nop 1
    ds_write_b128 v124, v[24:27]
    v_xor_b32 v8, 0x10000, v8
    v_xor_b32 v9, 0x10000, v9
    v_xor_b32 v10, 0x10000, v10
    v_xor_b32 v11, 0x10000, v11
    s_waitcnt vmcnt(15) lgkmcnt(0)
    s_barrier
    ds_read_b64_tr_b16 v[76:77], v8 offset:0
    ds_read_b64_tr_b16 v[78:79], v8 offset:512
    ds_read_b64_tr_b16 v[80:81], v9 offset:0
    ds_read_b64_tr_b16 v[82:83], v9 offset:512
    ds_read_b64_tr_b16 v[84:85], v10 offset:0
    ds_read_b64_tr_b16 v[86:87], v10 offset:512
    ds_read_b64_tr_b16 v[88:89], v11 offset:0
    ds_read_b64_tr_b16 v[90:91], v11 offset:512
    s_waitcnt lgkmcnt(6)
    v_mfma_f32_32x32x16_bf16 v[60:75], v[76:79], v[128:131], 0
    v_mfma_f32_16x16x32_bf16 v[24:27], v[76:79], v[16:19], 0
    ds_read_b64_tr_b16 v[92:93], v8 offset:8192
    ds_read_b64_tr_b16 v[94:95], v8 offset:8704
    v_and_b32 v124, 31, v0
    v_lshlrev_b32 v125, 6, v124
    v_and_b32 v127, 15, v0
    v_lshl_add_u32 v125, v127, 2, v125
    s_lshl_b32 s65, s60, 11
    s_add_u32 s65, s65, 147456
    s_waitcnt lgkmcnt(6)
    v_mfma_f32_32x32x16_bf16 v[60:75], v[80:83], v[132:135], v[60:75]
    ds_read_b64_tr_b16 v[76:77], v9 offset:8192
    ds_read_b64_tr_b16 v[78:79], v9 offset:8704
    v_add_u32 v125, s65, v125
    s_lshl_b32 s65, s60, 7
    s_add_u32 s65, s65, 155648
    v_lshl_add_u32 v127, v124, 2, s65
    ds_read_b32 v101, v125
    ds_read_b32 v100, v127
    s_mov_b32 s52, s22
    s_and_b32 s53, s23, 0xffff
    s_mov_b32 s54, 256
    s_mov_b32 s55, 0x00020000
    buffer_load_dwordx2 v[20:21], off, s[52:55], 0 sc1
    s_waitcnt lgkmcnt(8)
    v_mfma_f32_32x32x16_bf16 v[60:75], v[84:87], v[136:139], v[60:75]
    ds_read_b64_tr_b16 v[80:81], v10 offset:8192
    ds_read_b64_tr_b16 v[82:83], v10 offset:8704
    s_waitcnt lgkmcnt(2)
    v_mul_f32 v100, 0xbb000000, v100
    v_mul_f32 v101, 0x3b000000, v101
    v_fma_f32 v101, -v100, v100, v101
    v_max_f32 v101, 0, v101
    v_add_f32 v101, 0x3727c5ac, v101
    v_mfma_f32_32x32x16_bf16 v[60:75], v[88:91], v[140:143], v[60:75]
    ds_read_b64_tr_b16 v[84:85], v11 offset:8192
    ds_read_b64_tr_b16 v[86:87], v11 offset:8704
    v_rsq_f32 v36, v101
    v_sqrt_f32 v37, v101
    v_cvt_pk_bf16_f32 v104, v100, v100
    v_and_b32 v104, 0xffff0000, v104
    v_sub_f32 v105, v100, v104
    v_cvt_pk_bf16_f32 v28, v104, v105
    v_lshrrev_b32 v14, 3, v0
    v_lshlrev_b32 v14, 10, v14
    v_and_b32 v15, 7, v0
    v_lshrrev_b32 v2, 2, v0
    v_and_b32 v2, 4, v2
    v_xor_b32 v15, v15, v2
    v_lshl_add_u32 v2, v15, 4, v14
    s_bfe_u32 s70, s2, 0x30003
    s_and_b32 s26, s3, 1
    s_lshl_b32 s26, s26, 15
    s_lshl_b32 s70, s70, 7
    s_mul_i32 s75, s3, 229376
    s_add_u32 s70, s70, s75
    v_add_u32 v2, s70, v2
    s_lshl_b32 s17, s3, 11
    v_mfma_f32_32x32x16_bf16 v[60:75], v[92:95], v[144:147], v[60:75]
    v_mfma_f32_16x16x32_bf16 v[24:27], v[92:95], v[16:19], v[24:27]
    ds_read_b64_tr_b16 v[88:89], v8 offset:16384
    ds_read_b64_tr_b16 v[90:91], v8 offset:16896
    v_mov_b32 v29, v28
    v_cvt_pk_bf16_f32 v104, v37, v37
    v_and_b32 v104, 0xffff0000, v104
    v_sub_f32 v105, v37, v104
    v_cvt_pk_bf16_f32 v30, v104, v105
    v_mov_b32 v31, 0
    v_mfma_f32_32x32x16_bf16 v[60:75], v[76:79], v[148:151], v[60:75]
    ds_read_b64_tr_b16 v[92:93], v9 offset:16384
    ds_read_b64_tr_b16 v[94:95], v9 offset:16896
    v_mov_b32 v35, 0
    v_mov_b32 v34, 0
    v_mul_f32 v38, 0xc0135761, v36
    v_mul_f32 v39, v36, v36
    v_mul_f32 v39, v39, v36
    v_mul_f32 v39, 0xbdd2d3e8, v39
    s_mov_b32 m0, 160256
    s_add_u32 s70, s77, s27
    buffer_load_dword v13, s[12:15], s70 offen lds
    s_add_u32 s77, s77, 32768
    s_cmp_eq_u32 s77, 229376
    s_cselect_b32 s77, 0, s77
    s_waitcnt lgkmcnt(6)
    v_mfma_f32_32x32x16_bf16 v[60:75], v[80:83], v[152:155], v[60:75]
    ds_read_b64_tr_b16 v[76:77], v10 offset:16384
    ds_read_b64_tr_b16 v[78:79], v10 offset:16896
    s_waitcnt vmcnt(10)
    v_and_b32 v126, 31, v0
    s_lshl_b32 s65, s56, 9
    s_add_u32 s65, s65, 156160
    v_lshl_add_u32 v126, v126, 2, s65
    ds_read_b32 v100, v126 offset:0
    s_waitcnt lgkmcnt(7)
    v_mfma_f32_32x32x16_bf16 v[60:75], v[84:87], v[156:159], v[60:75]
    ds_read_b64_tr_b16 v[80:81], v11 offset:16384
    ds_read_b64_tr_b16 v[82:83], v11 offset:16896
    ds_read_b32 v101, v126 offset:128
    ds_read_b32 v102, v126 offset:256
    ds_read_b32 v103, v126 offset:384
    v_cmp_gt_u32 vcc, 32, v0
    s_waitcnt lgkmcnt(0)
    v_add_f32 v100, v100, v101
    s_mov_b32 m0, 160256
    s_add_u32 s70, s77, s27
    buffer_load_dword v13, s[12:15], s70 offen lds
    s_add_u32 s77, s77, 32768
    s_cmp_eq_u32 s77, 229376
    s_cselect_b32 s77, 0, s77
    v_mfma_f32_32x32x16_bf16 v[60:75], v[88:91], v[160:163], v[60:75]
    v_mfma_f32_16x16x32_bf16 v[24:27], v[88:91], v[16:19], v[24:27]
    ds_read_b64_tr_b16 v[84:85], v8 offset:24576
    ds_read_b64_tr_b16 v[86:87], v8 offset:25088
    v_add_f32 v102, v102, v103
    v_add_f32 v100, v100, v102
    v_cvt_pk_bf16_f32 v32, v100, v100
    v_and_b32 v101, 0xffff0000, v32
    v_sub_f32 v101, v100, v101
    v_cvt_pk_bf16_f32 v33, v101, v101
    v_cndmask_b32 v32, 0, v32, vcc
    v_mfma_f32_32x32x16_bf16 v[60:75], v[92:95], v[164:167], v[60:75]
    ds_read_b64_tr_b16 v[88:89], v9 offset:24576
    ds_read_b64_tr_b16 v[90:91], v9 offset:25088
    v_cndmask_b32 v33, 0, v33, vcc
    v_lshl_or_b32 v34, v40, 16, v40
    v_cndmask_b32 v34, 0, v34, vcc
    s_nop 1
    v_mfma_f32_32x32x16_bf16 v[44:59], v[32:35], v[28:31], v[44:59]
    s_mov_b32 m0, 160256
    s_add_u32 s70, s77, s27
    buffer_load_dword v13, s[12:15], s70 offen lds
    s_add_u32 s77, s77, 32768
    s_cmp_eq_u32 s77, 229376
    s_cselect_b32 s77, 0, s77
    v_mfma_f32_32x32x16_bf16 v[60:75], v[76:79], v[168:171], v[60:75]
    ds_read_b64_tr_b16 v[92:93], v10 offset:24576
    ds_read_b64_tr_b16 v[94:95], v10 offset:25088
    s_nop 7
    s_nop 7
    v_mul_f32 v100, v44, v44
    v_mul_f32 v101, v45, v45
    v_fma_f32 v100, v100, v39, v38
    v_fma_f32 v101, v101, v39, v38
    v_mul_f32 v102, v46, v46
    v_mfma_f32_32x32x16_bf16 v[60:75], v[80:83], v[172:175], v[60:75]
    ds_read_b64_tr_b16 v[76:77], v11 offset:24576
    ds_read_b64_tr_b16 v[78:79], v11 offset:25088
    v_mul_f32 v103, v47, v47
    v_mul_f32 v100, v100, v44
    v_mul_f32 v101, v101, v45
    v_fma_f32 v102, v102, v39, v38
    s_mov_b32 m0, 160256
    s_add_u32 s70, s77, s27
    buffer_load_dword v13, s[12:15], s70 offen lds
    s_add_u32 s77, s77, 32768
    s_cmp_eq_u32 s77, 229376
    s_cselect_b32 s77, 0, s77
    v_fma_f32 v103, v103, v39, v38
    s_waitcnt vmcnt(9)
    s_barrier
    s_waitcnt lgkmcnt(6)
    v_mfma_f32_32x32x16_bf16 v[60:75], v[84:87], v[176:179], v[60:75]
    v_mfma_f32_16x16x32_bf16 v[24:27], v[84:87], v[16:19], v[24:27]
    ds_read_b64_tr_b16 v[80:81], v8 offset:32768
    ds_read_b64_tr_b16 v[82:83], v8 offset:33280
    v_mul_f32 v104, v48, v48
    v_mul_f32 v105, v49, v49
    v_exp_f32 v100, v100
    v_exp_f32 v101, v101
    v_mul_f32 v102, v102, v46
    v_mul_f32 v103, v103, v47
    v_fma_f32 v104, v104, v39, v38
    s_waitcnt lgkmcnt(6)
    v_mfma_f32_32x32x16_bf16 v[60:75], v[88:91], v[180:183], v[60:75]
    ds_read_b64_tr_b16 v[84:85], v9 offset:32768
    ds_read_b64_tr_b16 v[86:87], v9 offset:33280
    v_fma_f32 v105, v105, v39, v38
    v_mul_f32 v106, v50, v50
    v_mul_f32 v107, v51, v51
    v_fma_f32 v100, v100, v37, v37
    s_mov_b32 m0, 160256
    s_add_u32 s70, s77, s27
    buffer_load_dword v13, s[12:15], s70 offen lds
    s_add_u32 s77, s77, 32768
    s_cmp_eq_u32 s77, 229376
    s_cselect_b32 s77, 0, s77
    v_fma_f32 v101, v101, v37, v37
    s_waitcnt lgkmcnt(6)
    v_mfma_f32_32x32x16_bf16 v[60:75], v[92:95], v[184:187], v[60:75]
    ds_read_b64_tr_b16 v[88:89], v10 offset:32768
    ds_read_b64_tr_b16 v[90:91], v10 offset:33280
    v_exp_f32 v102, v102
    v_exp_f32 v103, v103
    v_mul_f32 v104, v104, v48
    v_mul_f32 v105, v105, v49
    v_fma_f32 v106, v106, v39, v38
    v_fma_f32 v107, v107, v39, v38
    v_mul_f32 v108, v52, v52
    s_waitcnt lgkmcnt(6)
    v_mfma_f32_32x32x16_bf16 v[60:75], v[76:79], v[188:191], v[60:75]
    ds_read_b64_tr_b16 v[92:93], v11 offset:32768
    ds_read_b64_tr_b16 v[94:95], v11 offset:33280
    v_mul_f32 v109, v53, v53
    v_rcp_f32 v100, v100
    v_rcp_f32 v101, v101
    v_fma_f32 v102, v102, v37, v37
    s_mov_b32 m0, 160256
    s_add_u32 s70, s77, s27
    buffer_load_dword v13, s[12:15], s70 offen lds
    s_add_u32 s77, s77, 32768
    s_cmp_eq_u32 s77, 229376
    s_cselect_b32 s77, 0, s77
    v_fma_f32 v103, v103, v37, v37
    v_exp_f32 v104, v104
    s_waitcnt lgkmcnt(6)
    v_mfma_f32_32x32x16_bf16 v[60:75], v[80:83], v[192:195], v[60:75]
    v_mfma_f32_16x16x32_bf16 v[24:27], v[80:83], v[16:19], v[24:27]
    ds_read_b64_tr_b16 v[76:77], v8 offset:40960
    ds_read_b64_tr_b16 v[78:79], v8 offset:41472
    v_exp_f32 v105, v105
    v_mul_f32 v106, v106, v50
    v_mul_f32 v107, v107, v51
    v_fma_f32 v108, v108, v39, v38
    v_fma_f32 v109, v109, v39, v38
    v_mul_f32 v110, v54, v54
    s_waitcnt lgkmcnt(6)
    v_mfma_f32_32x32x16_bf16 v[60:75], v[84:87], v[196:199], v[60:75]
    ds_read_b64_tr_b16 v[80:81], v9 offset:40960
    ds_read_b64_tr_b16 v[82:83], v9 offset:41472
    v_mul_f32 v111, v55, v55
    v_mul_f32 v100, v100, v44
    v_mul_f32 v101, v101, v45
    v_rcp_f32 v102, v102
    s_mov_b32 m0, 160256
    s_add_u32 s70, s77, s27
    buffer_load_dword v13, s[12:15], s70 offen lds
    s_add_u32 s77, s77, 32768
    s_cmp_eq_u32 s77, 229376
    s_cselect_b32 s77, 0, s77
    v_rcp_f32 v103, v103
    v_fma_f32 v104, v104, v37, v37
    s_waitcnt lgkmcnt(6)
    v_mfma_f32_32x32x16_bf16 v[60:75], v[88:91], v[200:203], v[60:75]
    ds_read_b64_tr_b16 v[84:85], v10 offset:40960
    ds_read_b64_tr_b16 v[86:87], v10 offset:41472
    v_fma_f32 v105, v105, v37, v37
    v_exp_f32 v106, v106
    v_exp_f32 v107, v107
    v_mul_f32 v108, v108, v52
    v_mul_f32 v109, v109, v53
    v_fma_f32 v110, v110, v39, v38
    s_waitcnt lgkmcnt(6)
    v_mfma_f32_32x32x16_bf16 v[60:75], v[92:95], v[204:207], v[60:75]
    ds_read_b64_tr_b16 v[88:89], v11 offset:40960
    ds_read_b64_tr_b16 v[90:91], v11 offset:41472
    v_fma_f32 v111, v111, v39, v38
    v_mul_f32 v112, v56, v56
    v_mul_f32 v113, v57, v57
    v_cvt_pk_bf16_f32 v116, v100, v101
    s_mov_b32 m0, 160256
    s_lshl_b32 s70, s3, 16
    s_add_u32 s70, s70, 0
    buffer_load_dword v13, s[4:7], s70 offen lds
    v_mul_f32 v102, v102, v46
    v_mul_f32 v103, v103, v47
    s_waitcnt lgkmcnt(6)
    v_mfma_f32_32x32x16_bf16 v[60:75], v[76:79], v[208:211], v[60:75]
    v_mfma_f32_16x16x32_bf16 v[24:27], v[76:79], v[16:19], v[24:27]
    ds_read_b64_tr_b16 v[92:93], v8 offset:49152
    ds_read_b64_tr_b16 v[94:95], v8 offset:49664
    v_rcp_f32 v104, v104
    v_rcp_f32 v105, v105
    v_fma_f32 v106, v106, v37, v37
    v_fma_f32 v107, v107, v37, v37
    v_exp_f32 v108, v108
    v_exp_f32 v109, v109
    s_waitcnt lgkmcnt(6)
    v_mfma_f32_32x32x16_bf16 v[60:75], v[80:83], v[212:215], v[60:75]
    ds_read_b64_tr_b16 v[76:77], v9 offset:49152
    ds_read_b64_tr_b16 v[78:79], v9 offset:49664
    v_mul_f32 v110, v110, v54
    v_mul_f32 v111, v111, v55
    v_fma_f32 v112, v112, v39, v38
    s_mov_b32 m0, 160256
    s_lshl_b32 s70, s3, 16
    s_add_u32 s70, s70, 32768
    buffer_load_dword v13, s[4:7], s70 offen lds
    v_fma_f32 v113, v113, v39, v38
    v_mul_f32 v114, v58, v58
    v_mul_f32 v115, v59, v59
    s_waitcnt lgkmcnt(6)
    v_mfma_f32_32x32x16_bf16 v[60:75], v[84:87], v[216:219], v[60:75]
    ds_read_b64_tr_b16 v[80:81], v10 offset:49152
    ds_read_b64_tr_b16 v[82:83], v10 offset:49664
    v_cvt_pk_bf16_f32 v117, v102, v103
    v_mul_f32 v104, v104, v48
    v_mul_f32 v105, v105, v49
    v_rcp_f32 v106, v106
    v_rcp_f32 v107, v107
    v_fma_f32 v108, v108, v37, v37
    v_fma_f32 v109, v109, v37, v37
    s_waitcnt lgkmcnt(6)
    v_mfma_f32_32x32x16_bf16 v[60:75], v[88:91], v[220:223], v[60:75]
    ds_read_b64_tr_b16 v[84:85], v11 offset:49152
    ds_read_b64_tr_b16 v[86:87], v11 offset:49664
    v_exp_f32 v110, v110
    v_exp_f32 v111, v111
    v_mul_f32 v112, v112, v56
    v_mul_f32 v113, v113, v57
    v_fma_f32 v114, v114, v39, v38
    v_fma_f32 v115, v115, v39, v38
    s_waitcnt lgkmcnt(6)
    v_mfma_f32_32x32x16_bf16 v[60:75], v[92:95], v[224:227], v[60:75]
    v_mfma_f32_16x16x32_bf16 v[24:27], v[92:95], v[16:19], v[24:27]
    ds_read_b64_tr_b16 v[88:89], v8 offset:57344
    ds_read_b64_tr_b16 v[90:91], v8 offset:57856
    v_cvt_pk_bf16_f32 v118, v104, v105
    v_mul_f32 v106, v106, v50
    v_mul_f32 v107, v107, v51
    v_rcp_f32 v108, v108
    v_rcp_f32 v109, v109
    v_fma_f32 v110, v110, v37, v37
    v_fma_f32 v111, v111, v37, v37
    s_waitcnt lgkmcnt(6)
    v_mfma_f32_32x32x16_bf16 v[60:75], v[76:79], v[228:231], v[60:75]
    ds_read_b64_tr_b16 v[92:93], v9 offset:57344
    ds_read_b64_tr_b16 v[94:95], v9 offset:57856
    v_exp_f32 v112, v112
    v_exp_f32 v113, v113
    v_mul_f32 v114, v114, v58
    v_mul_f32 v115, v115, v59
    v_cvt_pk_bf16_f32 v119, v106, v107
    s_add_u32 s66, s68, 0
    s_waitcnt lgkmcnt(6)
    v_mfma_f32_32x32x16_bf16 v[60:75], v[80:83], v[232:235], v[60:75]
    ds_read_b64_tr_b16 v[76:77], v10 offset:57344
    ds_read_b64_tr_b16 v[78:79], v10 offset:57856
    buffer_store_dwordx4 v[116:119], v23, s[36:39], s66 offen sc1
    v_mul_f32 v108, v108, v52
    v_mul_f32 v109, v109, v53
    v_rcp_f32 v110, v110
    v_rcp_f32 v111, v111
    v_fma_f32 v112, v112, v37, v37
    v_fma_f32 v113, v113, v37, v37
    s_waitcnt lgkmcnt(6)
    v_mfma_f32_32x32x16_bf16 v[60:75], v[84:87], v[236:239], v[60:75]
    ds_read_b64_tr_b16 v[80:81], v11 offset:57344
    ds_read_b64_tr_b16 v[82:83], v11 offset:57856
    v_exp_f32 v114, v114
    v_exp_f32 v115, v115
    v_cvt_pk_bf16_f32 v120, v108, v109
    v_mul_f32 v110, v110, v54
    v_mul_f32 v111, v111, v55
    v_rcp_f32 v112, v112
    s_waitcnt lgkmcnt(6)
    v_mfma_f32_32x32x16_bf16 v[60:75], v[88:91], v[240:243], v[60:75]
    v_mfma_f32_16x16x32_bf16 v[24:27], v[88:91], v[16:19], v[24:27]
    v_rcp_f32 v113, v113
    v_fma_f32 v114, v114, v37, v37
    v_fma_f32 v115, v115, v37, v37
    v_cvt_pk_bf16_f32 v121, v110, v111
    v_mul_f32 v112, v112, v56
    v_mul_f32 v113, v113, v57
    v_rcp_f32 v114, v114
    s_waitcnt lgkmcnt(4)
    v_mfma_f32_32x32x16_bf16 v[60:75], v[92:95], v[244:247], v[60:75]
    v_rcp_f32 v115, v115
    v_cvt_pk_bf16_f32 v122, v112, v113
    v_mul_f32 v114, v114, v58
    v_mul_f32 v115, v115, v59
    v_cvt_pk_bf16_f32 v123, v114, v115
    s_add_u32 s66, s68, 1024
    buffer_store_dwordx4 v[120:123], v23, s[36:39], s66 offen sc1
    s_waitcnt lgkmcnt(2)
    v_mfma_f32_32x32x16_bf16 v[60:75], v[76:79], v[248:251], v[60:75]
    s_waitcnt lgkmcnt(0)
    v_mfma_f32_32x32x16_bf16 v[60:75], v[80:83], v[252:255], v[60:75]
    v_and_b32 v124, 1, v0
    v_lshlrev_b32 v124, 6, v124
    v_lshrrev_b32 v125, 4, v0
    v_lshl_add_u32 v124, v125, 4, v124
    s_lshl_b32 s65, s3, 7
    s_add_u32 s65, s65, 157184
    v_add_u32 v124, s65, v124
    s_nop 1
    ds_write_b128 v124, v[24:27]
    v_xor_b32 v8, 0x10000, v8
    v_xor_b32 v9, 0x10000, v9
    v_xor_b32 v10, 0x10000, v10
    v_xor_b32 v11, 0x10000, v11
    s_waitcnt vmcnt(11) lgkmcnt(0)
    s_barrier
    v_cmp_eq_u32 vcc, 0, v21
    s_nop 1
    s_cbranch_vccz .Ltok1_ok
    s_mov_b32 s75, 32768
.Ltok1_lp:
    s_sleep 8
    buffer_load_dwordx2 v[20:21], off, s[52:55], 0 sc1
    s_waitcnt vmcnt(0)
    v_cmp_eq_u32 vcc, 0, v21
    s_nop 1
    s_cbranch_vccz .Ltok1_ok
    s_sub_u32 s75, s75, 1
    s_cmp_lg_u32 s75, 0
    s_cbranch_scc1 .Ltok1_lp
.Ltok1_ok:
    s_add_u32 s52, s24, 11010048
    s_addc_u32 s53, s25, 0
    s_and_b32 s53, s53, 0xffff
    s_mov_b32 s54, 131072
    s_mov_b32 s55, 0x00020000
    s_lshr_b32 s76, s60, 1
    s_lshl_b32 s76, s76, 3
    s_add_u32 s76, s76, s59
    s_lshl_b32 s76, s76, 8
    s_and_b32 s70, s60, 1
    s_lshl_b32 s70, s70, 4
    s_add_u32 s76, s76, s70
    s_lshl_b32 s70, s56, 3
    s_add_u32 s76, s76, s70
    s_lshl_b32 s70, s58, 12
    s_add_u32 s76, s76, s70
    s_add_u32 s76, s76, 32
    ds_read_b64_tr_b16 v[76:77], v8 offset:0
    ds_read_b64_tr_b16 v[78:79], v8 offset:512
    ds_read_b64_tr_b16 v[80:81], v9 offset:0
    ds_read_b64_tr_b16 v[82:83], v9 offset:512
    ds_read_b64_tr_b16 v[84:85], v10 offset:0
    ds_read_b64_tr_b16 v[86:87], v10 offset:512
    ds_read_b64_tr_b16 v[88:89], v11 offset:0
    ds_read_b64_tr_b16 v[90:91], v11 offset:512
    s_waitcnt lgkmcnt(6)
    v_mfma_f32_32x32x16_bf16 v[44:59], v[76:79], v[128:131], 0
    v_mfma_f32_16x16x32_bf16 v[24:27], v[76:79], v[16:19], 0
    ds_read_b64_tr_b16 v[92:93], v8 offset:8192
    ds_read_b64_tr_b16 v[94:95], v8 offset:8704
    v_and_b32 v126, 31, v0
    s_lshl_b32 s65, s56, 9
    s_add_u32 s65, s65, 157184
    v_lshl_add_u32 v126, v126, 2, s65
    ds_read_b32 v100, v126 offset:0
    s_waitcnt lgkmcnt(7)
    v_mfma_f32_32x32x16_bf16 v[44:59], v[80:83], v[132:135], v[44:59]
    ds_read_b64_tr_b16 v[76:77], v9 offset:8192
    ds_read_b64_tr_b16 v[78:79], v9 offset:8704
    ds_read_b32 v101, v126 offset:128
    ds_read_b32 v102, v126 offset:256
    ds_read_b32 v103, v126 offset:384
    v_cmp_gt_u32 vcc, 32, v0
    s_waitcnt lgkmcnt(0)
    v_mfma_f32_32x32x16_bf16 v[44:59], v[84:87], v[136:139], v[44:59]
    ds_read_b64_tr_b16 v[80:81], v10 offset:8192
    ds_read_b64_tr_b16 v[82:83], v10 offset:8704
    s_add_u32 s70, s72, 0
    s_and_b32 s70, s70, 3
    s_add_u32 m0, s44, 65536
    s_lshl_b32 s75, s71, 1
    s_xor_b32 s70, s70, s75
    s_mul_i32 s70, s70, 458752
    s_add_u32 s70, s70, s61
    buffer_load_dwordx4 v3, s[32:35], s70 offen lds
    v_add_f32 v100, v100, v101
    v_add_f32 v102, v102, v103
    v_add_f32 v100, v100, v102
    v_cvt_pk_bf16_f32 v32, v100, v100
    v_and_b32 v101, 0xffff0000, v32
    v_mfma_f32_32x32x16_bf16 v[44:59], v[88:91], v[140:143], v[44:59]
    ds_read_b64_tr_b16 v[84:85], v11 offset:8192
    ds_read_b64_tr_b16 v[86:87], v11 offset:8704
    v_sub_f32 v101, v100, v101
    v_cvt_pk_bf16_f32 v33, v101, v101
    v_cndmask_b32 v32, 0, v32, vcc
    v_cndmask_b32 v33, 0, v33, vcc
    s_add_u32 s70, s72, 1
    s_and_b32 s70, s70, 3
    s_add_u32 m0, s45, 65536
    s_lshl_b32 s75, s71, 1
    s_xor_b32 s70, s70, s75
    s_mul_i32 s70, s70, 458752
    s_add_u32 s70, s70, s61
    buffer_load_dwordx4 v3, s[32:35], s70 offen lds
    v_mfma_f32_32x32x16_bf16 v[44:59], v[92:95], v[144:147], v[44:59]
    v_mfma_f32_16x16x32_bf16 v[24:27], v[92:95], v[16:19], v[24:27]
    ds_read_b64_tr_b16 v[88:89], v8 offset:16384
    ds_read_b64_tr_b16 v[90:91], v8 offset:16896
    v_lshl_or_b32 v34, v41, 16, v41
    v_cndmask_b32 v34, 0, v34, vcc
    s_nop 1
    v_mfma_f32_32x32x16_bf16 v[60:75], v[32:35], v[28:31], v[60:75]
    s_nop 7
    v_mfma_f32_32x32x16_bf16 v[44:59], v[76:79], v[148:151], v[44:59]
    ds_read_b64_tr_b16 v[92:93], v9 offset:16384
    ds_read_b64_tr_b16 v[94:95], v9 offset:16896
    s_nop 7
    v_mul_f32 v100, v60, v60
    v_mul_f32 v101, v61, v61
    v_fma_f32 v100, v100, v39, v38
    s_add_u32 s70, s72, 2
    s_and_b32 s70, s70, 3
    s_add_u32 m0, s46, 65536
    s_lshl_b32 s75, s71, 1
    s_xor_b32 s70, s70, s75
    s_mul_i32 s70, s70, 458752
    s_add_u32 s70, s70, s61
    buffer_load_dwordx4 v3, s[32:35], s70 offen lds
    v_fma_f32 v101, v101, v39, v38
    s_waitcnt lgkmcnt(6)
    v_mfma_f32_32x32x16_bf16 v[44:59], v[80:83], v[152:155], v[44:59]
    ds_read_b64_tr_b16 v[76:77], v10 offset:16384
    ds_read_b64_tr_b16 v[78:79], v10 offset:16896
    v_mul_f32 v102, v62, v62
    v_mul_f32 v103, v63, v63
    v_mul_f32 v100, v100, v60
    v_mul_f32 v101, v101, v61
    v_fma_f32 v102, v102, v39, v38
    s_waitcnt lgkmcnt(6)
    v_mfma_f32_32x32x16_bf16 v[44:59], v[84:87], v[156:159], v[44:59]
    ds_read_b64_tr_b16 v[80:81], v11 offset:16384
    ds_read_b64_tr_b16 v[82:83], v11 offset:16896
    v_fma_f32 v103, v103, v39, v38
    v_mul_f32 v104, v64, v64
    v_mul_f32 v105, v65, v65
    s_add_u32 s70, s72, 3
    s_and_b32 s70, s70, 3
    s_add_u32 m0, s47, 65536
    s_lshl_b32 s75, s71, 1
    s_xor_b32 s70, s70, s75
    s_mul_i32 s70, s70, 458752
    s_add_u32 s70, s70, s61
    buffer_load_dwordx4 v3, s[32:35], s70 offen lds
    v_exp_f32 v100, v100
    s_waitcnt lgkmcnt(6)
    v_mfma_f32_32x32x16_bf16 v[44:59], v[88:91], v[160:163], v[44:59]
    v_mfma_f32_16x16x32_bf16 v[24:27], v[88:91], v[16:19], v[24:27]
    ds_read_b64_tr_b16 v[84:85], v8 offset:24576
    ds_read_b64_tr_b16 v[86:87], v8 offset:25088
    v_exp_f32 v101, v101
    v_mul_f32 v102, v102, v62
    v_mul_f32 v103, v103, v63
    v_fma_f32 v104, v104, v39, v38
    v_fma_f32 v105, v105, v39, v38
    v_mul_f32 v106, v66, v66
    s_waitcnt lgkmcnt(6)
    v_mfma_f32_32x32x16_bf16 v[44:59], v[92:95], v[164:167], v[44:59]
    ds_read_b64_tr_b16 v[88:89], v9 offset:24576
    ds_read_b64_tr_b16 v[90:91], v9 offset:25088
    v_mul_f32 v107, v67, v67
    v_fma_f32 v100, v100, v37, v37
    v_fma_f32 v101, v101, v37, v37
    v_exp_f32 v102, v102
    v_exp_f32 v103, v103
    s_waitcnt lgkmcnt(6)
    v_mfma_f32_32x32x16_bf16 v[44:59], v[76:79], v[168:171], v[44:59]
    ds_read_b64_tr_b16 v[92:93], v10 offset:24576
    ds_read_b64_tr_b16 v[94:95], v10 offset:25088
    v_mul_f32 v104, v104, v64
    v_mul_f32 v105, v105, v65
    v_fma_f32 v106, v106, v39, v38
    v_fma_f32 v107, v107, v39, v38
    v_mul_f32 v108, v68, v68
    s_waitcnt lgkmcnt(6)
    v_mfma_f32_32x32x16_bf16 v[44:59], v[80:83], v[172:175], v[44:59]
    ds_read_b64_tr_b16 v[76:77], v11 offset:24576
    ds_read_b64_tr_b16 v[78:79], v11 offset:25088
    v_mul_f32 v109, v69, v69
    v_rcp_f32 v100, v100
    v_rcp_f32 v101, v101
    v_fma_f32 v102, v102, v37, v37
    v_fma_f32 v103, v103, v37, v37
    v_exp_f32 v104, v104
    s_waitcnt lgkmcnt(6)
    v_mfma_f32_32x32x16_bf16 v[44:59], v[84:87], v[176:179], v[44:59]
    v_mfma_f32_16x16x32_bf16 v[24:27], v[84:87], v[16:19], v[24:27]
    ds_read_b64_tr_b16 v[80:81], v8 offset:32768
    ds_read_b64_tr_b16 v[82:83], v8 offset:33280
    v_exp_f32 v105, v105
    v_mul_f32 v106, v106, v66
    v_mul_f32 v107, v107, v67
    v_fma_f32 v108, v108, v39, v38
    v_fma_f32 v109, v109, v39, v38
    s_waitcnt lgkmcnt(6)
    v_mfma_f32_32x32x16_bf16 v[44:59], v[88:91], v[180:183], v[44:59]
    ds_read_b64_tr_b16 v[84:85], v9 offset:32768
    ds_read_b64_tr_b16 v[86:87], v9 offset:33280
    v_mul_f32 v110, v70, v70
    v_mul_f32 v111, v71, v71
    v_mul_f32 v100, v100, v60
    v_mul_f32 v101, v101, v61
    v_rcp_f32 v102, v102
    s_waitcnt lgkmcnt(6)
    v_mfma_f32_32x32x16_bf16 v[44:59], v[92:95], v[184:187], v[44:59]
    ds_read_b64_tr_b16 v[88:89], v10 offset:32768
    ds_read_b64_tr_b16 v[90:91], v10 offset:33280
    v_rcp_f32 v103, v103
    v_fma_f32 v104, v104, v37, v37
    v_fma_f32 v105, v105, v37, v37
    v_exp_f32 v106, v106
    v_exp_f32 v107, v107
    v_mul_f32 v108, v108, v68
    s_waitcnt lgkmcnt(6)
    v_mfma_f32_32x32x16_bf16 v[44:59], v[76:79], v[188:191], v[44:59]
    ds_read_b64_tr_b16 v[92:93], v11 offset:32768
    ds_read_b64_tr_b16 v[94:95], v11 offset:33280
    v_mul_f32 v109, v109, v69
    v_fma_f32 v110, v110, v39, v38
    v_fma_f32 v111, v111, v39, v38
    v_mul_f32 v112, v72, v72
    v_mul_f32 v113, v73, v73
    s_waitcnt lgkmcnt(6)
    v_mfma_f32_32x32x16_bf16 v[44:59], v[80:83], v[192:195], v[44:59]
    v_mfma_f32_16x16x32_bf16 v[24:27], v[80:83], v[16:19], v[24:27]
    ds_read_b64_tr_b16 v[76:77], v8 offset:40960
    ds_read_b64_tr_b16 v[78:79], v8 offset:41472
    v_cvt_pk_bf16_f32 v116, v100, v101
    v_mul_f32 v102, v102, v62
    v_mul_f32 v103, v103, v63
    v_rcp_f32 v104, v104
    v_rcp_f32 v105, v105
    s_waitcnt lgkmcnt(6)
    v_mfma_f32_32x32x16_bf16 v[44:59], v[84:87], v[196:199], v[44:59]
    ds_read_b64_tr_b16 v[80:81], v9 offset:40960
    ds_read_b64_tr_b16 v[82:83], v9 offset:41472
    v_fma_f32 v106, v106, v37, v37
    v_fma_f32 v107, v107, v37, v37
    v_exp_f32 v108, v108
    v_exp_f32 v109, v109
    s_add_u32 m0, s17, 98304
    s_nop 0
    buffer_load_dwordx4 v2, s[12:15], s26 offen lds
    v_mul_f32 v110, v110, v70
    s_waitcnt lgkmcnt(6)
    v_mfma_f32_32x32x16_bf16 v[44:59], v[88:91], v[200:203], v[44:59]
    ds_read_b64_tr_b16 v[84:85], v10 offset:40960
    ds_read_b64_tr_b16 v[86:87], v10 offset:41472
    v_mul_f32 v111, v111, v71
    v_fma_f32 v112, v112, v39, v38
    v_fma_f32 v113, v113, v39, v38
    v_mul_f32 v114, v74, v74
    v_mul_f32 v115, v75, v75
    s_waitcnt lgkmcnt(6)
    v_mfma_f32_32x32x16_bf16 v[44:59], v[92:95], v[204:207], v[44:59]
    ds_read_b64_tr_b16 v[88:89], v11 offset:40960
    ds_read_b64_tr_b16 v[90:91], v11 offset:41472
    v_cvt_pk_bf16_f32 v117, v102, v103
    v_mul_f32 v104, v104, v64
    v_mul_f32 v105, v105, v65
    v_rcp_f32 v106, v106
    s_add_u32 m0, s17, 99328
    s_add_u32 s70, s26, 8192
    buffer_load_dwordx4 v2, s[12:15], s70 offen lds
    s_add_u32 s26, s26, 16384
    s_cmp_eq_u32 s26, 229376
    s_cselect_b32 s26, 0, s26
    s_waitcnt lgkmcnt(6)
    v_mfma_f32_32x32x16_bf16 v[44:59], v[76:79], v[208:211], v[44:59]
    v_mfma_f32_16x16x32_bf16 v[24:27], v[76:79], v[16:19], v[24:27]
    ds_read_b64_tr_b16 v[92:93], v8 offset:49152
    ds_read_b64_tr_b16 v[94:95], v8 offset:49664
    v_rcp_f32 v107, v107
    v_fma_f32 v108, v108, v37, v37
    v_fma_f32 v109, v109, v37, v37
    v_exp_f32 v110, v110
    v_exp_f32 v111, v111
    v_mul_f32 v112, v112, v72
    s_waitcnt lgkmcnt(6)
    v_mfma_f32_32x32x16_bf16 v[44:59], v[80:83], v[212:215], v[44:59]
    ds_read_b64_tr_b16 v[76:77], v9 offset:49152
    ds_read_b64_tr_b16 v[78:79], v9 offset:49664
    v_mul_f32 v113, v113, v73
    v_fma_f32 v114, v114, v39, v38
    v_fma_f32 v115, v115, v39, v38
    v_cvt_pk_bf16_f32 v118, v104, v105
    s_add_u32 m0, s17, 114688
    s_nop 0
    buffer_load_dwordx4 v2, s[12:15], s26 offen lds
    s_waitcnt lgkmcnt(6)
    v_mfma_f32_32x32x16_bf16 v[44:59], v[84:87], v[216:219], v[44:59]
    ds_read_b64_tr_b16 v[80:81], v10 offset:49152
    ds_read_b64_tr_b16 v[82:83], v10 offset:49664
    v_mul_f32 v106, v106, v66
    v_mul_f32 v107, v107, v67
    v_rcp_f32 v108, v108
    v_rcp_f32 v109, v109
    v_fma_f32 v110, v110, v37, v37
    s_waitcnt lgkmcnt(6)
    v_mfma_f32_32x32x16_bf16 v[44:59], v[88:91], v[220:223], v[44:59]
    ds_read_b64_tr_b16 v[84:85], v11 offset:49152
    ds_read_b64_tr_b16 v[86:87], v11 offset:49664
    v_fma_f32 v111, v111, v37, v37
    v_exp_f32 v112, v112
    v_exp_f32 v113, v113
    v_mul_f32 v114, v114, v74
    v_mul_f32 v115, v115, v75
    s_add_u32 m0, s17, 115712
    s_add_u32 s70, s26, 8192
    buffer_load_dwordx4 v2, s[12:15], s70 offen lds
    s_add_u32 s26, s26, 16384
    s_cmp_eq_u32 s26, 229376
    s_cselect_b32 s26, 0, s26
    s_waitcnt lgkmcnt(6)
    v_mfma_f32_32x32x16_bf16 v[44:59], v[92:95], v[224:227], v[44:59]
    v_mfma_f32_16x16x32_bf16 v[24:27], v[92:95], v[16:19], v[24:27]
    ds_read_b64_tr_b16 v[88:89], v8 offset:57344
    ds_read_b64_tr_b16 v[90:91], v8 offset:57856
    v_cvt_pk_bf16_f32 v119, v106, v107
    s_add_u32 s66, s68, 4096
    buffer_store_dwordx4 v[116:119], v23, s[36:39], s66 offen sc1
    v_mul_f32 v108, v108, v68
    v_mul_f32 v109, v109, v69
    s_waitcnt lgkmcnt(6)
    v_mfma_f32_32x32x16_bf16 v[44:59], v[76:79], v[228:231], v[44:59]
    ds_read_b64_tr_b16 v[92:93], v9 offset:57344
    ds_read_b64_tr_b16 v[94:95], v9 offset:57856
    v_rcp_f32 v110, v110
    v_rcp_f32 v111, v111
    v_fma_f32 v112, v112, v37, v37
    v_fma_f32 v113, v113, v37, v37
    v_exp_f32 v114, v114
    s_waitcnt lgkmcnt(6)
    v_mfma_f32_32x32x16_bf16 v[44:59], v[80:83], v[232:235], v[44:59]
    ds_read_b64_tr_b16 v[76:77], v10 offset:57344
    ds_read_b64_tr_b16 v[78:79], v10 offset:57856
    s_add_u32 m0, s17, 131072
    s_nop 0
    buffer_load_dwordx4 v2, s[12:15], s26 offen lds
    v_exp_f32 v115, v115
    v_cvt_pk_bf16_f32 v120, v108, v109
    v_mul_f32 v110, v110, v70
    v_mul_f32 v111, v111, v71
    v_rcp_f32 v112, v112
    s_waitcnt lgkmcnt(6)
    v_mfma_f32_32x32x16_bf16 v[44:59], v[84:87], v[236:239], v[44:59]
    ds_read_b64_tr_b16 v[80:81], v11 offset:57344
    ds_read_b64_tr_b16 v[82:83], v11 offset:57856
    v_rcp_f32 v113, v113
    v_fma_f32 v114, v114, v37, v37
    v_fma_f32 v115, v115, v37, v37
    v_cvt_pk_bf16_f32 v121, v110, v111
    v_mul_f32 v112, v112, v72
    s_waitcnt lgkmcnt(6)
    v_mfma_f32_32x32x16_bf16 v[44:59], v[88:91], v[240:243], v[44:59]
    v_mfma_f32_16x16x32_bf16 v[24:27], v[88:91], v[16:19], v[24:27]
    s_add_u32 m0, s17, 132096
    s_add_u32 s70, s26, 8192
    buffer_load_dwordx4 v2, s[12:15], s70 offen lds
    s_add_u32 s26, s26, 16384
    s_cmp_eq_u32 s26, 229376
    s_cselect_b32 s26, 0, s26
    v_mul_f32 v113, v113, v73
    v_rcp_f32 v114, v114
    v_rcp_f32 v115, v115
    v_cvt_pk_bf16_f32 v122, v112, v113
    s_waitcnt lgkmcnt(4)
    v_mfma_f32_32x32x16_bf16 v[44:59], v[92:95], v[244:247], v[44:59]
    v_mul_f32 v114, v114, v74
    v_mul_f32 v115, v115, v75
    v_cvt_pk_bf16_f32 v123, v114, v115
    s_add_u32 s66, s68, 5120
    buffer_store_dwordx4 v[120:123], v23, s[36:39], s66 offen sc1
    s_waitcnt lgkmcnt(2)
    v_mfma_f32_32x32x16_bf16 v[44:59], v[76:79], v[248:251], v[44:59]
    s_waitcnt lgkmcnt(0)
    v_mfma_f32_32x32x16_bf16 v[44:59], v[80:83], v[252:255], v[44:59]
    v_and_b32 v124, 1, v0
    v_lshlrev_b32 v124, 6, v124
    v_lshrrev_b32 v125, 4, v0
    v_lshl_add_u32 v124, v125, 4, v124
    s_lshl_b32 s65, s3, 7
    s_add_u32 s65, s65, 156160
    v_add_u32 v124, s65, v124
    s_nop 1
    ds_write_b128 v124, v[24:27]
    v_xor_b32 v8, 0, v12
    v_xor_b32 v9, 1024, v12
    v_xor_b32 v10, 2048, v12
    v_xor_b32 v11, 3072, v12
    s_waitcnt vmcnt(8) lgkmcnt(0)
    s_barrier
    s_cmp_lg_u32 s56, 0
    s_cbranch_scc1 .Lp1_Bg1
    ds_read_b64_tr_b16 v[76:77], v8 offset:0
    ds_read_b64_tr_b16 v[78:79], v8 offset:256
    ds_read_b64_tr_b16 v[80:81], v9 offset:0
    ds_read_b64_tr_b16 v[82:83], v9 offset:256
    ds_read_b64_tr_b16 v[84:85], v10 offset:0
    ds_read_b64_tr_b16 v[86:87], v10 offset:256
    ds_read_b64_tr_b16 v[88:89], v11 offset:0
    ds_read_b64_tr_b16 v[90:91], v11 offset:256
    s_waitcnt lgkmcnt(6)
    v_mfma_f32_32x32x16_bf16 v[60:75], v[76:79], v[128:131], 0
    v_mfma_f32_16x16x32_bf16 v[24:27], v[76:79], v[16:19], 0
    ds_read_b64_tr_b16 v[92:93], v8 offset:4096
    ds_read_b64_tr_b16 v[94:95], v8 offset:4352
    v_and_b32 v126, 31, v0
    s_lshl_b32 s65, s56, 9
    s_add_u32 s65, s65, 156160
    v_lshl_add_u32 v126, v126, 2, s65
    ds_read_b32 v100, v126 offset:0
    s_waitcnt lgkmcnt(7)
    v_mfma_f32_32x32x16_bf16 v[60:75], v[80:83], v[132:135], v[60:75]
    v_mfma_f32_16x16x32_bf16 v[24:27], v[80:83], v[16:19], v[24:27]
    ds_read_b64_tr_b16 v[76:77], v9 offset:4096
    ds_read_b64_tr_b16 v[78:79], v9 offset:4352
    ds_read_b32 v101, v126 offset:128
    ds_read_b32 v102, v126 offset:256
    ds_read_b32 v103, v126 offset:384
    s_add_u32 m0, s17, 0
    s_nop 0
    buffer_load_dwordx4 v2, s[12:15], s26 offen lds
    v_cmp_gt_u32 vcc, 32, v0
    s_waitcnt lgkmcnt(10)
    v_mfma_f32_32x32x16_bf16 v[60:75], v[84:87], v[136:139], v[60:75]
    v_mfma_f32_16x16x32_bf16 v[24:27], v[84:87], v[16:19], v[24:27]
    ds_read_b64_tr_b16 v[80:81], v10 offset:4096
    ds_read_b64_tr_b16 v[82:83], v10 offset:4352
    s_waitcnt lgkmcnt(2)
    v_add_f32 v100, v100, v101
    v_add_f32 v102, v102, v103
    v_add_f32 v100, v100, v102
    v_cvt_pk_bf16_f32 v32, v100, v100
    v_mfma_f32_32x32x16_bf16 v[60:75], v[88:91], v[140:143], v[60:75]
    v_mfma_f32_16x16x32_bf16 v[24:27], v[88:91], v[16:19], v[24:27]
    ds_read_b64_tr_b16 v[84:85], v11 offset:4096
    ds_read_b64_tr_b16 v[86:87], v11 offset:4352
    v_and_b32 v101, 0xffff0000, v32
    s_add_u32 m0, s17, 1024
    s_add_u32 s70, s26, 8192
    buffer_load_dwordx4 v2, s[12:15], s70 offen lds
    s_add_u32 s26, s26, 16384
    s_cmp_eq_u32 s26, 229376
    s_cselect_b32 s26, 0, s26
    v_sub_f32 v101, v100, v101
    v_cvt_pk_bf16_f32 v33, v101, v101
    v_cndmask_b32 v32, 0, v32, vcc
    v_cndmask_b32 v33, 0, v33, vcc
    v_mfma_f32_32x32x16_bf16 v[60:75], v[92:95], v[144:147], v[60:75]
    v_mfma_f32_16x16x32_bf16 v[24:27], v[92:95], v[16:19], v[24:27]
    ds_read_b64_tr_b16 v[88:89], v8 offset:8192
    ds_read_b64_tr_b16 v[90:91], v8 offset:8448
    v_lshl_or_b32 v34, v42, 16, v42
    v_cndmask_b32 v34, 0, v34, vcc
    s_nop 1
    v_mfma_f32_32x32x16_bf16 v[44:59], v[32:35], v[28:31], v[44:59]
    s_add_u32 m0, s17, 16384
    s_nop 0
    buffer_load_dwordx4 v2, s[12:15], s26 offen lds
    v_mfma_f32_32x32x16_bf16 v[60:75], v[76:79], v[148:151], v[60:75]
    v_mfma_f32_16x16x32_bf16 v[24:27], v[76:79], v[16:19], v[24:27]
    ds_read_b64_tr_b16 v[92:93], v9 offset:8192
    ds_read_b64_tr_b16 v[94:95], v9 offset:8448
    s_nop 7
    s_nop 7
    v_mul_f32 v100, v44, v44
    v_mul_f32 v101, v45, v45
    v_fma_f32 v100, v100, v39, v38
    s_waitcnt lgkmcnt(6)
    v_mfma_f32_32x32x16_bf16 v[60:75], v[80:83], v[152:155], v[60:75]
    v_mfma_f32_16x16x32_bf16 v[24:27], v[80:83], v[16:19], v[24:27]
    ds_read_b64_tr_b16 v[76:77], v10 offset:8192
    ds_read_b64_tr_b16 v[78:79], v10 offset:8448
    v_fma_f32 v101, v101, v39, v38
    v_mul_f32 v102, v46, v46
    s_add_u32 m0, s17, 17408
    s_add_u32 s70, s26, 8192
    buffer_load_dwordx4 v2, s[12:15], s70 offen lds
    s_add_u32 s26, s26, 16384
    s_cmp_eq_u32 s26, 229376
    s_cselect_b32 s26, 0, s26
    v_mul_f32 v103, v47, v47
    v_mul_f32 v100, v100, v44
    s_waitcnt lgkmcnt(6)
    v_mfma_f32_32x32x16_bf16 v[60:75], v[84:87], v[156:159], v[60:75]
    v_mfma_f32_16x16x32_bf16 v[24:27], v[84:87], v[16:19], v[24:27]
    ds_read_b64_tr_b16 v[80:81], v11 offset:8192
    ds_read_b64_tr_b16 v[82:83], v11 offset:8448
    v_mul_f32 v101, v101, v45
    v_fma_f32 v102, v102, v39, v38
    v_fma_f32 v103, v103, v39, v38
    v_mul_f32 v104, v48, v48
    v_mul_f32 v105, v49, v49
    s_add_u32 m0, s17, 32768
    s_nop 0
    buffer_load_dwordx4 v2, s[12:15], s26 offen lds
    s_waitcnt lgkmcnt(6)
    v_mfma_f32_32x32x16_bf16 v[60:75], v[88:91], v[160:163], v[60:75]
    v_mfma_f32_16x16x32_bf16 v[24:27], v[88:91], v[16:19], v[24:27]
    ds_read_b64_tr_b16 v[84:85], v8 offset:12288
    ds_read_b64_tr_b16 v[86:87], v8 offset:12544
    v_exp_f32 v100, v100
    v_exp_f32 v101, v101
    v_mul_f32 v102, v102, v46
    v_mul_f32 v103, v103, v47
    v_fma_f32 v104, v104, v39, v38
    s_waitcnt lgkmcnt(6)
    v_mfma_f32_32x32x16_bf16 v[60:75], v[92:95], v[164:167], v[60:75]
    v_mfma_f32_16x16x32_bf16 v[24:27], v[92:95], v[16:19], v[24:27]
    ds_read_b64_tr_b16 v[88:89], v9 offset:12288
    ds_read_b64_tr_b16 v[90:91], v9 offset:12544
    v_fma_f32 v105, v105, v39, v38
    v_mul_f32 v106, v50, v50
    v_mul_f32 v107, v51, v51
    s_add_u32 m0, s17, 33792
    s_add_u32 s70, s26, 8192
    buffer_load_dwordx4 v2, s[12:15], s70 offen lds
    s_add_u32 s26, s26, 16384
    s_cmp_eq_u32 s26, 229376
    s_cselect_b32 s26, 0, s26
    v_fma_f32 v100, v100, v37, v37
    s_waitcnt lgkmcnt(6)
    v_mfma_f32_32x32x16_bf16 v[60:75], v[76:79], v[168:171], v[60:75]
    v_mfma_f32_16x16x32_bf16 v[24:27], v[76:79], v[16:19], v[24:27]
    ds_read_b64_tr_b16 v[92:93], v10 offset:12288
    ds_read_b64_tr_b16 v[94:95], v10 offset:12544
    v_fma_f32 v101, v101, v37, v37
    v_exp_f32 v102, v102
    v_exp_f32 v103, v103
    v_mul_f32 v104, v104, v48
    v_mul_f32 v105, v105, v49
    s_waitcnt lgkmcnt(6)
    v_mfma_f32_32x32x16_bf16 v[60:75], v[80:83], v[172:175], v[60:75]
    v_mfma_f32_16x16x32_bf16 v[24:27], v[80:83], v[16:19], v[24:27]
    ds_read_b64_tr_b16 v[76:77], v11 offset:12288
    ds_read_b64_tr_b16 v[78:79], v11 offset:12544
    v_fma_f32 v106, v106, v39, v38
    s_add_u32 m0, s17, 49152
    s_nop 0
    buffer_load_dwordx4 v2, s[12:15], s26 offen lds
    v_fma_f32 v107, v107, v39, v38
    v_mul_f32 v108, v52, v52
    v_mul_f32 v109, v53, v53
    v_rcp_f32 v100, v100
    s_waitcnt lgkmcnt(6)
    v_mfma_f32_32x32x16_bf16 v[60:75], v[84:87], v[176:179], v[60:75]
    v_mfma_f32_16x16x32_bf16 v[24:27], v[84:87], v[16:19], v[24:27]
    ds_read_b64_tr_b16 v[80:81], v8 offset:16384
    ds_read_b64_tr_b16 v[82:83], v8 offset:16640
    v_rcp_f32 v101, v101
    v_fma_f32 v102, v102, v37, v37
    v_fma_f32 v103, v103, v37, v37
    s_add_u32 m0, s17, 50176
    s_add_u32 s70, s26, 8192
    buffer_load_dwordx4 v2, s[12:15], s70 offen lds
    s_add_u32 s26, s26, 16384
    s_cmp_eq_u32 s26, 229376
    s_cselect_b32 s26, 0, s26
    v_exp_f32 v104, v104
    s_waitcnt lgkmcnt(6)
    v_mfma_f32_32x32x16_bf16 v[60:75], v[88:91], v[180:183], v[60:75]
    v_mfma_f32_16x16x32_bf16 v[24:27], v[88:91], v[16:19], v[24:27]
    ds_read_b64_tr_b16 v[84:85], v9 offset:16384
    ds_read_b64_tr_b16 v[86:87], v9 offset:16640
    v_exp_f32 v105, v105
    v_mul_f32 v106, v106, v50
    v_mul_f32 v107, v107, v51
    v_fma_f32 v108, v108, v39, v38
    v_fma_f32 v109, v109, v39, v38
    s_waitcnt lgkmcnt(6)
    v_mfma_f32_32x32x16_bf16 v[60:75], v[92:95], v[184:187], v[60:75]
    v_mfma_f32_16x16x32_bf16 v[24:27], v[92:95], v[16:19], v[24:27]
    ds_read_b64_tr_b16 v[88:89], v10 offset:16384
    ds_read_b64_tr_b16 v[90:91], v10 offset:16640
    v_mul_f32 v110, v54, v54
    v_mul_f32 v111, v55, v55
    v_mul_f32 v100, v100, v44
    v_mul_f32 v101, v101, v45
    v_rcp_f32 v102, v102
    v_rcp_f32 v103, v103
    s_waitcnt lgkmcnt(6)
    v_mfma_f32_32x32x16_bf16 v[60:75], v[76:79], v[188:191], v[60:75]
    v_mfma_f32_16x16x32_bf16 v[24:27], v[76:79], v[16:19], v[24:27]
    ds_read_b64_tr_b16 v[92:93], v11 offset:16384
    ds_read_b64_tr_b16 v[94:95], v11 offset:16640
    v_fma_f32 v104, v104, v37, v37
    v_fma_f32 v105, v105, v37, v37
    v_exp_f32 v106, v106
    v_exp_f32 v107, v107
    v_mul_f32 v108, v108, v52
    s_waitcnt lgkmcnt(6)
    v_mfma_f32_32x32x16_bf16 v[60:75], v[80:83], v[192:195], v[60:75]
    v_mfma_f32_16x16x32_bf16 v[24:27], v[80:83], v[16:19], v[24:27]
    ds_read_b64_tr_b16 v[76:77], v8 offset:20480
    ds_read_b64_tr_b16 v[78:79], v8 offset:20736
    v_mul_f32 v109, v109, v53
    v_fma_f32 v110, v110, v39, v38
    v_fma_f32 v111, v111, v39, v38
    v_mul_f32 v112, v56, v56
    v_mul_f32 v113, v57, v57
    s_waitcnt lgkmcnt(6)
    v_mfma_f32_32x32x16_bf16 v[60:75], v[84:87], v[196:199], v[60:75]
    v_mfma_f32_16x16x32_bf16 v[24:27], v[84:87], v[16:19], v[24:27]
    ds_read_b64_tr_b16 v[80:81], v9 offset:20480
    ds_read_b64_tr_b16 v[82:83], v9 offset:20736
    v_cvt_pk_bf16_f32 v116, v100, v101
    v_mul_f32 v102, v102, v46
    v_mul_f32 v103, v103, v47
    v_rcp_f32 v104, v104
    v_rcp_f32 v105, v105
    s_waitcnt lgkmcnt(6)
    v_mfma_f32_32x32x16_bf16 v[60:75], v[88:91], v[200:203], v[60:75]
    v_mfma_f32_16x16x32_bf16 v[24:27], v[88:91], v[16:19], v[24:27]
    ds_read_b64_tr_b16 v[84:85], v10 offset:20480
    ds_read_b64_tr_b16 v[86:87], v10 offset:20736
    s_waitcnt vmcnt(8)
    s_mov_b64 exec, 1
    buffer_store_dwordx2 v[20:21], off, s[52:55], s76 offset:64 sc1
    s_mov_b64 exec, -1
    v_fma_f32 v106, v106, v37, v37
    v_fma_f32 v107, v107, v37, v37
    v_exp_f32 v108, v108
    v_exp_f32 v109, v109
    v_mul_f32 v110, v110, v54
    s_waitcnt lgkmcnt(6)
    v_mfma_f32_32x32x16_bf16 v[60:75], v[92:95], v[204:207], v[60:75]
    v_mfma_f32_16x16x32_bf16 v[24:27], v[92:95], v[16:19], v[24:27]
    ds_read_b64_tr_b16 v[88:89], v11 offset:20480
    ds_read_b64_tr_b16 v[90:91], v11 offset:20736
    v_mul_f32 v111, v111, v55
    v_fma_f32 v112, v112, v39, v38
    v_fma_f32 v113, v113, v39, v38
    v_mul_f32 v114, v58, v58
    v_mul_f32 v115, v59, v59
    s_waitcnt lgkmcnt(6)
    v_mfma_f32_32x32x16_bf16 v[60:75], v[76:79], v[208:211], v[60:75]
    v_mfma_f32_16x16x32_bf16 v[24:27], v[76:79], v[16:19], v[24:27]
    ds_read_b64_tr_b16 v[92:93], v8 offset:24576
    ds_read_b64_tr_b16 v[94:95], v8 offset:24832
    v_cvt_pk_bf16_f32 v117, v102, v103
    v_mul_f32 v104, v104, v48
    v_mul_f32 v105, v105, v49
    v_rcp_f32 v106, v106
    v_rcp_f32 v107, v107
    s_waitcnt lgkmcnt(6)
    v_mfma_f32_32x32x16_bf16 v[60:75], v[80:83], v[212:215], v[60:75]
    v_mfma_f32_16x16x32_bf16 v[24:27], v[80:83], v[16:19], v[24:27]
    ds_read_b64_tr_b16 v[76:77], v9 offset:24576
    ds_read_b64_tr_b16 v[78:79], v9 offset:24832
    v_fma_f32 v108, v108, v37, v37
    v_fma_f32 v109, v109, v37, v37
    v_exp_f32 v110, v110
    v_exp_f32 v111, v111
    v_mul_f32 v112, v112, v56
    s_waitcnt lgkmcnt(6)
    v_mfma_f32_32x32x16_bf16 v[60:75], v[84:87], v[216:219], v[60:75]
    v_mfma_f32_16x16x32_bf16 v[24:27], v[84:87], v[16:19], v[24:27]
    ds_read_b64_tr_b16 v[80:81], v10 offset:24576
    ds_read_b64_tr_b16 v[82:83], v10 offset:24832
    v_mul_f32 v113, v113, v57
    v_fma_f32 v114, v114, v39, v38
    v_fma_f32 v115, v115, v39, v38
    v_cvt_pk_bf16_f32 v118, v104, v105
    v_mul_f32 v106, v106, v50
    v_mul_f32 v107, v107, v51
    s_waitcnt lgkmcnt(6)
    v_mfma_f32_32x32x16_bf16 v[60:75], v[88:91], v[220:223], v[60:75]
    v_mfma_f32_16x16x32_bf16 v[24:27], v[88:91], v[16:19], v[24:27]
    ds_read_b64_tr_b16 v[84:85], v11 offset:24576
    ds_read_b64_tr_b16 v[86:87], v11 offset:24832
    v_rcp_f32 v108, v108
    v_rcp_f32 v109, v109
    v_fma_f32 v110, v110, v37, v37
    v_fma_f32 v111, v111, v37, v37
    v_exp_f32 v112, v112
    s_waitcnt lgkmcnt(6)
    v_mfma_f32_32x32x16_bf16 v[60:75], v[92:95], v[224:227], v[60:75]
    v_mfma_f32_16x16x32_bf16 v[24:27], v[92:95], v[16:19], v[24:27]
    ds_read_b64_tr_b16 v[88:89], v8 offset:28672
    ds_read_b64_tr_b16 v[90:91], v8 offset:28928
    v_exp_f32 v113, v113
    v_mul_f32 v114, v114, v58
    v_mul_f32 v115, v115, v59
    v_cvt_pk_bf16_f32 v119, v106, v107
    s_add_u32 s66, s68, 8192
    s_waitcnt lgkmcnt(6)
    v_mfma_f32_32x32x16_bf16 v[60:75], v[76:79], v[228:231], v[60:75]
    v_mfma_f32_16x16x32_bf16 v[24:27], v[76:79], v[16:19], v[24:27]
    ds_read_b64_tr_b16 v[92:93], v9 offset:28672
    ds_read_b64_tr_b16 v[94:95], v9 offset:28928
    buffer_store_dwordx4 v[116:119], v23, s[36:39], s66 offen sc1
    v_mul_f32 v108, v108, v52
    v_mul_f32 v109, v109, v53
    v_rcp_f32 v110, v110
    v_rcp_f32 v111, v111
    s_waitcnt lgkmcnt(6)
    v_mfma_f32_32x32x16_bf16 v[60:75], v[80:83], v[232:235], v[60:75]
    v_mfma_f32_16x16x32_bf16 v[24:27], v[80:83], v[16:19], v[24:27]
    ds_read_b64_tr_b16 v[76:77], v10 offset:28672
    ds_read_b64_tr_b16 v[78:79], v10 offset:28928
    v_fma_f32 v112, v112, v37, v37
    v_fma_f32 v113, v113, v37, v37
    v_exp_f32 v114, v114
    v_exp_f32 v115, v115
    v_cvt_pk_bf16_f32 v120, v108, v109
    v_mul_f32 v110, v110, v54
    s_waitcnt lgkmcnt(6)
    v_mfma_f32_32x32x16_bf16 v[60:75], v[84:87], v[236:239], v[60:75]
    v_mfma_f32_16x16x32_bf16 v[24:27], v[84:87], v[16:19], v[24:27]
    ds_read_b64_tr_b16 v[80:81], v11 offset:28672
    ds_read_b64_tr_b16 v[82:83], v11 offset:28928
    v_mul_f32 v111, v111, v55
    v_rcp_f32 v112, v112
    v_rcp_f32 v113, v113
    v_fma_f32 v114, v114, v37, v37
    v_fma_f32 v115, v115, v37, v37
    s_waitcnt lgkmcnt(6)
    v_mfma_f32_32x32x16_bf16 v[60:75], v[88:91], v[240:243], v[60:75]
    v_mfma_f32_16x16x32_bf16 v[24:27], v[88:91], v[16:19], v[24:27]
    v_cvt_pk_bf16_f32 v121, v110, v111
    v_mul_f32 v112, v112, v56
    v_mul_f32 v113, v113, v57
    v_rcp_f32 v114, v114
    v_rcp_f32 v115, v115
    s_waitcnt lgkmcnt(4)
    v_mfma_f32_32x32x16_bf16 v[60:75], v[92:95], v[244:247], v[60:75]
    v_mfma_f32_16x16x32_bf16 v[24:27], v[92:95], v[16:19], v[24:27]
    v_cvt_pk_bf16_f32 v122, v112, v113
    v_mul_f32 v114, v114, v58
    v_mul_f32 v115, v115, v59
    v_cvt_pk_bf16_f32 v123, v114, v115
    s_add_u32 s66, s68, 9216
    buffer_store_dwordx4 v[120:123], v23, s[36:39], s66 offen sc1
    s_waitcnt lgkmcnt(2)
    v_mfma_f32_32x32x16_bf16 v[60:75], v[76:79], v[248:251], v[60:75]
    v_mfma_f32_16x16x32_bf16 v[24:27], v[76:79], v[16:19], v[24:27]
    s_waitcnt lgkmcnt(0)
    v_mfma_f32_32x32x16_bf16 v[60:75], v[80:83], v[252:255], v[60:75]
    v_mfma_f32_16x16x32_bf16 v[24:27], v[80:83], v[16:19], v[24:27]
    v_and_b32 v124, 1, v0
    v_lshlrev_b32 v124, 6, v124
    v_lshrrev_b32 v125, 4, v0
    v_lshl_add_u32 v124, v125, 4, v124
    s_lshl_b32 s65, s3, 7
    s_add_u32 s65, s65, 157184
    v_add_u32 v124, s65, v124
    s_nop 1
    ds_write_b128 v124, v[24:27]
    s_lshl_b32 s65, s60, 2
    s_add_u32 s65, s65, 159744
    v_mov_b32 v127, s65
    ds_write_b32 v127, v22
    v_and_b32 v126, 31, v0
    s_lshl_b32 s65, s3, 7
    s_add_u32 s65, s65, 157184
    v_lshl_add_u32 v126, v126, 2, s65
    ds_read_b32 v100, v126 offset:0
    v_cmp_gt_u32 vcc, 32, v0
    s_waitcnt lgkmcnt(0)
    v_cvt_pk_bf16_f32 v32, v100, v100
    v_and_b32 v101, 0xffff0000, v32
    v_sub_f32 v101, v100, v101
    v_cvt_pk_bf16_f32 v33, v101, v101
    v_cndmask_b32 v32, 0, v32, vcc
    v_cndmask_b32 v33, 0, v33, vcc
    v_lshl_or_b32 v34, v43, 16, v43
    v_cndmask_b32 v34, 0, v34, vcc
    s_nop 1
    v_mfma_f32_32x32x16_bf16 v[60:75], v[32:35], v[28:31], v[60:75]
    s_nop 7
    s_nop 7
    v_pk_mul_f32 v[100:101], v[60:61], v[60:61]
    v_pk_mul_f32 v[102:103], v[62:63], v[62:63]
    v_pk_mul_f32 v[104:105], v[64:65], v[64:65]
    v_pk_mul_f32 v[106:107], v[66:67], v[66:67]
    v_pk_fma_f32 v[100:101], v[100:101], v[38:39], v[38:39] op_sel:[0,1,0] op_sel_hi:[1,1,0]
    v_pk_fma_f32 v[102:103], v[102:103], v[38:39], v[38:39] op_sel:[0,1,0] op_sel_hi:[1,1,0]
    v_pk_fma_f32 v[104:105], v[104:105], v[38:39], v[38:39] op_sel:[0,1,0] op_sel_hi:[1,1,0]
    v_pk_fma_f32 v[106:107], v[106:107], v[38:39], v[38:39] op_sel:[0,1,0] op_sel_hi:[1,1,0]
    v_pk_mul_f32 v[100:101], v[100:101], v[60:61]
    v_pk_mul_f32 v[102:103], v[102:103], v[62:63]
    v_pk_mul_f32 v[104:105], v[104:105], v[64:65]
    v_pk_mul_f32 v[106:107], v[106:107], v[66:67]
    v_exp_f32 v100, v100
    v_exp_f32 v101, v101
    v_exp_f32 v102, v102
    v_exp_f32 v103, v103
    v_exp_f32 v104, v104
    v_exp_f32 v105, v105
    v_exp_f32 v106, v106
    v_exp_f32 v107, v107
    v_pk_fma_f32 v[100:101], v[100:101], v[36:37], v[36:37] op_sel:[0,1,1] op_sel_hi:[1,1,1]
    v_pk_fma_f32 v[102:103], v[102:103], v[36:37], v[36:37] op_sel:[0,1,1] op_sel_hi:[1,1,1]
    v_pk_fma_f32 v[104:105], v[104:105], v[36:37], v[36:37] op_sel:[0,1,1] op_sel_hi:[1,1,1]
    v_pk_fma_f32 v[106:107], v[106:107], v[36:37], v[36:37] op_sel:[0,1,1] op_sel_hi:[1,1,1]
    v_rcp_f32 v100, v100
    v_rcp_f32 v101, v101
    v_rcp_f32 v102, v102
    v_rcp_f32 v103, v103
    v_rcp_f32 v104, v104
    v_rcp_f32 v105, v105
    v_rcp_f32 v106, v106
    v_rcp_f32 v107, v107
    v_pk_mul_f32 v[100:101], v[100:101], v[60:61]
    v_pk_mul_f32 v[102:103], v[102:103], v[62:63]
    v_pk_mul_f32 v[104:105], v[104:105], v[64:65]
    v_pk_mul_f32 v[106:107], v[106:107], v[66:67]
    v_cvt_pk_bf16_f32 v116, v100, v101
    v_cvt_pk_bf16_f32 v117, v102, v103
    v_cvt_pk_bf16_f32 v118, v104, v105
    v_cvt_pk_bf16_f32 v119, v106, v107
    s_add_u32 s66, s69, 0
    buffer_store_dwordx4 v[116:119], v23, s[36:39], s66 offen sc1
    v_pk_mul_f32 v[108:109], v[68:69], v[68:69]
    v_pk_mul_f32 v[110:111], v[70:71], v[70:71]
    v_pk_mul_f32 v[112:113], v[72:73], v[72:73]
    v_pk_mul_f32 v[114:115], v[74:75], v[74:75]
    v_pk_fma_f32 v[108:109], v[108:109], v[38:39], v[38:39] op_sel:[0,1,0] op_sel_hi:[1,1,0]
    v_pk_fma_f32 v[110:111], v[110:111], v[38:39], v[38:39] op_sel:[0,1,0] op_sel_hi:[1,1,0]
    v_pk_fma_f32 v[112:113], v[112:113], v[38:39], v[38:39] op_sel:[0,1,0] op_sel_hi:[1,1,0]
    v_pk_fma_f32 v[114:115], v[114:115], v[38:39], v[38:39] op_sel:[0,1,0] op_sel_hi:[1,1,0]
    v_pk_mul_f32 v[108:109], v[108:109], v[68:69]
    v_pk_mul_f32 v[110:111], v[110:111], v[70:71]
    v_pk_mul_f32 v[112:113], v[112:113], v[72:73]
    v_pk_mul_f32 v[114:115], v[114:115], v[74:75]
    v_exp_f32 v108, v108
    v_exp_f32 v109, v109
    v_exp_f32 v110, v110
    v_exp_f32 v111, v111
    v_exp_f32 v112, v112
    v_exp_f32 v113, v113
    v_exp_f32 v114, v114
    v_exp_f32 v115, v115
    v_pk_fma_f32 v[108:109], v[108:109], v[36:37], v[36:37] op_sel:[0,1,1] op_sel_hi:[1,1,1]
    v_pk_fma_f32 v[110:111], v[110:111], v[36:37], v[36:37] op_sel:[0,1,1] op_sel_hi:[1,1,1]
    v_pk_fma_f32 v[112:113], v[112:113], v[36:37], v[36:37] op_sel:[0,1,1] op_sel_hi:[1,1,1]
    v_pk_fma_f32 v[114:115], v[114:115], v[36:37], v[36:37] op_sel:[0,1,1] op_sel_hi:[1,1,1]
    v_rcp_f32 v108, v108
    v_rcp_f32 v109, v109
    v_rcp_f32 v110, v110
    v_rcp_f32 v111, v111
    v_rcp_f32 v112, v112
    v_rcp_f32 v113, v113
    v_rcp_f32 v114, v114
    v_rcp_f32 v115, v115
    v_pk_mul_f32 v[108:109], v[108:109], v[68:69]
    v_pk_mul_f32 v[110:111], v[110:111], v[70:71]
    v_pk_mul_f32 v[112:113], v[112:113], v[72:73]
    v_pk_mul_f32 v[114:115], v[114:115], v[74:75]
    v_cvt_pk_bf16_f32 v120, v108, v109
    v_cvt_pk_bf16_f32 v121, v110, v111
    v_cvt_pk_bf16_f32 v122, v112, v113
    v_cvt_pk_bf16_f32 v123, v114, v115
    s_add_u32 s66, s69, 1024
    buffer_store_dwordx4 v[120:123], v23, s[36:39], s66 offen sc1
    s_waitcnt vmcnt(5)
    s_branch .Lp2
.Lp1_Bg1:
    v_and_b32 v126, 31, v0
    s_lshl_b32 s65, s56, 9
    s_add_u32 s65, s65, 156160
    v_lshl_add_u32 v126, v126, 2, s65
    ds_read_b32 v100, v126 offset:0
    ds_read_b32 v101, v126 offset:128
    ds_read_b32 v102, v126 offset:256
    ds_read_b32 v103, v126 offset:384
    s_add_u32 m0, s17, 0
    s_nop 0
    buffer_load_dwordx4 v2, s[12:15], s26 offen lds
    v_cmp_gt_u32 vcc, 32, v0
    s_waitcnt lgkmcnt(0)
    v_add_f32 v100, v100, v101
    v_add_f32 v102, v102, v103
    v_add_f32 v100, v100, v102
    v_cvt_pk_bf16_f32 v32, v100, v100
    v_and_b32 v101, 0xffff0000, v32
    s_add_u32 m0, s17, 1024
    s_add_u32 s70, s26, 8192
    buffer_load_dwordx4 v2, s[12:15], s70 offen lds
    s_add_u32 s26, s26, 16384
    s_cmp_eq_u32 s26, 229376
    s_cselect_b32 s26, 0, s26
    v_sub_f32 v101, v100, v101
    v_cvt_pk_bf16_f32 v33, v101, v101
    v_cndmask_b32 v32, 0, v32, vcc
    v_cndmask_b32 v33, 0, v33, vcc
    v_lshl_or_b32 v34, v42, 16, v42
    v_cndmask_b32 v34, 0, v34, vcc
    s_nop 1
    v_mfma_f32_32x32x16_bf16 v[44:59], v[32:35], v[28:31], v[44:59]
    s_add_u32 m0, s17, 16384
    s_nop 0
    buffer_load_dwordx4 v2, s[12:15], s26 offen lds
    s_nop 7
    s_nop 7
    v_mul_f32 v100, v44, v44
    v_mul_f32 v101, v45, v45
    v_fma_f32 v100, v100, v39, v38
    v_fma_f32 v101, v101, v39, v38
    v_mul_f32 v102, v46, v46
    s_add_u32 m0, s17, 17408
    s_add_u32 s70, s26, 8192
    buffer_load_dwordx4 v2, s[12:15], s70 offen lds
    s_add_u32 s26, s26, 16384
    s_cmp_eq_u32 s26, 229376
    s_cselect_b32 s26, 0, s26
    v_mul_f32 v103, v47, v47
    v_mul_f32 v100, v100, v44
    v_mul_f32 v101, v101, v45
    v_fma_f32 v102, v102, v39, v38
    v_fma_f32 v103, v103, v39, v38
    v_mul_f32 v104, v48, v48
    v_mul_f32 v105, v49, v49
    s_add_u32 m0, s17, 32768
    s_nop 0
    buffer_load_dwordx4 v2, s[12:15], s26 offen lds
    v_exp_f32 v100, v100
    v_exp_f32 v101, v101
    v_mul_f32 v102, v102, v46
    v_mul_f32 v103, v103, v47
    v_fma_f32 v104, v104, v39, v38
    v_fma_f32 v105, v105, v39, v38
    v_mul_f32 v106, v50, v50
    v_mul_f32 v107, v51, v51
    s_add_u32 m0, s17, 33792
    s_add_u32 s70, s26, 8192
    buffer_load_dwordx4 v2, s[12:15], s70 offen lds
    s_add_u32 s26, s26, 16384
    s_cmp_eq_u32 s26, 229376
    s_cselect_b32 s26, 0, s26
    v_fma_f32 v100, v100, v37, v37
    v_fma_f32 v101, v101, v37, v37
    v_exp_f32 v102, v102
    v_exp_f32 v103, v103
    v_mul_f32 v104, v104, v48
    v_mul_f32 v105, v105, v49
    v_fma_f32 v106, v106, v39, v38
    s_add_u32 m0, s17, 49152
    s_nop 0
    buffer_load_dwordx4 v2, s[12:15], s26 offen lds
    v_fma_f32 v107, v107, v39, v38
    v_mul_f32 v108, v52, v52
    v_mul_f32 v109, v53, v53
    v_rcp_f32 v100, v100
    v_rcp_f32 v101, v101
    v_fma_f32 v102, v102, v37, v37
    v_fma_f32 v103, v103, v37, v37
    s_add_u32 m0, s17, 50176
    s_add_u32 s70, s26, 8192
    buffer_load_dwordx4 v2, s[12:15], s70 offen lds
    s_add_u32 s26, s26, 16384
    s_cmp_eq_u32 s26, 229376
    s_cselect_b32 s26, 0, s26
    v_exp_f32 v104, v104
    v_exp_f32 v105, v105
    v_mul_f32 v106, v106, v50
    v_mul_f32 v107, v107, v51
    v_fma_f32 v108, v108, v39, v38
    v_fma_f32 v109, v109, v39, v38
    v_mul_f32 v110, v54, v54
    v_mul_f32 v111, v55, v55
    v_mul_f32 v100, v100, v44
    v_mul_f32 v101, v101, v45
    v_rcp_f32 v102, v102
    v_rcp_f32 v103, v103
    v_fma_f32 v104, v104, v37, v37
    v_fma_f32 v105, v105, v37, v37
    v_exp_f32 v106, v106
    v_exp_f32 v107, v107
    v_mul_f32 v108, v108, v52
    v_mul_f32 v109, v109, v53
    v_fma_f32 v110, v110, v39, v38
    v_fma_f32 v111, v111, v39, v38
    v_mul_f32 v112, v56, v56
    v_mul_f32 v113, v57, v57
    v_cvt_pk_bf16_f32 v116, v100, v101
    v_mul_f32 v102, v102, v46
    v_mul_f32 v103, v103, v47
    v_rcp_f32 v104, v104
    v_rcp_f32 v105, v105
    s_waitcnt vmcnt(8)
    s_mov_b64 exec, 1
    buffer_store_dwordx2 v[20:21], off, s[52:55], s76 offset:64 sc1
    s_mov_b64 exec, -1
    v_fma_f32 v106, v106, v37, v37
    v_fma_f32 v107, v107, v37, v37
    v_exp_f32 v108, v108
    v_exp_f32 v109, v109
    v_mul_f32 v110, v110, v54
    v_mul_f32 v111, v111, v55
    v_fma_f32 v112, v112, v39, v38
    v_fma_f32 v113, v113, v39, v38
    v_mul_f32 v114, v58, v58
    v_mul_f32 v115, v59, v59
    v_cvt_pk_bf16_f32 v117, v102, v103
    v_mul_f32 v104, v104, v48
    v_mul_f32 v105, v105, v49
    v_rcp_f32 v106, v106
    v_rcp_f32 v107, v107
    v_fma_f32 v108, v108, v37, v37
    v_fma_f32 v109, v109, v37, v37
    v_exp_f32 v110, v110
    v_exp_f32 v111, v111
    v_mul_f32 v112, v112, v56
    v_mul_f32 v113, v113, v57
    v_fma_f32 v114, v114, v39, v38
    v_fma_f32 v115, v115, v39, v38
    v_cvt_pk_bf16_f32 v118, v104, v105
    v_mul_f32 v106, v106, v50
    v_mul_f32 v107, v107, v51
    v_rcp_f32 v108, v108
    v_rcp_f32 v109, v109
    v_fma_f32 v110, v110, v37, v37
    v_fma_f32 v111, v111, v37, v37
    v_exp_f32 v112, v112
    v_exp_f32 v113, v113
    v_mul_f32 v114, v114, v58
    v_mul_f32 v115, v115, v59
    v_cvt_pk_bf16_f32 v119, v106, v107
    s_add_u32 s66, s68, 8192
    buffer_store_dwordx4 v[116:119], v23, s[36:39], s66 offen sc1
    v_mul_f32 v108, v108, v52
    v_mul_f32 v109, v109, v53
    v_rcp_f32 v110, v110
    v_rcp_f32 v111, v111
    v_fma_f32 v112, v112, v37, v37
    v_fma_f32 v113, v113, v37, v37
    v_exp_f32 v114, v114
    v_exp_f32 v115, v115
    v_cvt_pk_bf16_f32 v120, v108, v109
    v_mul_f32 v110, v110, v54
    v_mul_f32 v111, v111, v55
    v_rcp_f32 v112, v112
    v_rcp_f32 v113, v113
    v_fma_f32 v114, v114, v37, v37
    v_fma_f32 v115, v115, v37, v37
    v_cvt_pk_bf16_f32 v121, v110, v111
    v_mul_f32 v112, v112, v56
    v_mul_f32 v113, v113, v57
    v_rcp_f32 v114, v114
    v_rcp_f32 v115, v115
    v_cvt_pk_bf16_f32 v122, v112, v113
    v_mul_f32 v114, v114, v58
    v_mul_f32 v115, v115, v59
    v_cvt_pk_bf16_f32 v123, v114, v115
    s_add_u32 s66, s68, 9216
    buffer_store_dwordx4 v[120:123], v23, s[36:39], s66 offen sc1
    s_waitcnt vmcnt(3)
    s_branch .Lp2
.Lp1_A:
    v_lshrrev_b32 v124, 3, v0
    s_lshl_b32 s65, s3, 3
    v_add_u32 v124, s65, v124
    v_mul_u32_u24 v124, 3072, v124
    v_and_b32 v125, 7, v0
    v_lshrrev_b32 v126, 2, v0
    v_and_b32 v126, 4, v126
    v_xor_b32 v125, v125, v126
    v_lshl_add_u32 v2, v125, 4, v124
    s_lshl_b32 s64, s59, 7
    s_mov_b32 s32, s6
    s_and_b32 s33, s7, 0xffff
    s_mov_b32 s34, 1572864
    s_mov_b32 s35, 0x00020000
    s_lshl_b32 s70, s71, 9
    s_add_u32 s40, s63, s70
    s_sub_u32 s41, s63, s70
    s_mul_i32 s73, s71, 786432
    s_add_u32 s42, s64, s73
    s_sub_u32 s43, s64, s73
    s_add_u32 m0, s62, 98304
    s_add_u32 s70, s40, 0
    buffer_load_dwordx4 v1, s[28:31], s70 offen lds
    s_add_u32 m0, s62, 106496
    s_add_u32 s70, s40, 65536
    buffer_load_dwordx4 v1, s[28:31], s70 offen lds
    s_add_u32 m0, s62, 0
    s_add_u32 s70, s42, 1024
    buffer_load_dwordx4 v2, s[32:35], s70 offen lds
    s_setprio 2
    s_add_u32 m0, s62, 114688
    s_add_u32 s70, s40, 128
    buffer_load_dwordx4 v1, s[28:31], s70 offen lds
    s_add_u32 m0, s62, 122880
    s_add_u32 s70, s40, 65664
    buffer_load_dwordx4 v1, s[28:31], s70 offen lds
    s_add_u32 m0, s62, 8192
    s_add_u32 s70, s42, 197632
    buffer_load_dwordx4 v2, s[32:35], s70 offen lds
    s_xor_b32 s74, s73, 786432
    s_add_u32 s70, s72, 0
    s_and_b32 s70, s70, 3
    s_lshl_b32 s44, s70, 13
    s_add_u32 s44, s44, s62
    s_mul_i32 s48, s70, 196608
    s_add_u32 s48, s48, s64
    s_add_u32 s70, s72, 1
    s_and_b32 s70, s70, 3
    s_lshl_b32 s45, s70, 13
    s_add_u32 s45, s45, s62
    s_mul_i32 s49, s70, 196608
    s_add_u32 s49, s49, s64
    s_add_u32 s70, s72, 2
    s_and_b32 s70, s70, 3
    s_lshl_b32 s46, s70, 13
    s_add_u32 s46, s46, s62
    s_mul_i32 s50, s70, 196608
    s_add_u32 s50, s50, s64
    s_add_u32 s70, s72, 3
    s_and_b32 s70, s70, 3
    s_lshl_b32 s47, s70, 13
    s_add_u32 s47, s47, s62
    s_mul_i32 s51, s70, 196608
    s_add_u32 s51, s51, s64
    s_or_b32 s65, s2, s3
    s_cmp_lg_u32 s65, 0
    s_cbranch_scc1 .Lnopub
    s_memrealtime s[26:27]
    s_mov_b32 s52, s22
    s_and_b32 s53, s23, 0xffff
    s_mov_b32 s54, 256
    s_mov_b32 s55, 0x00020000
    s_waitcnt lgkmcnt(0)
    s_or_b32 s27, s27, 0x40000000
    v_mov_b32 v20, s26
    v_mov_b32 v21, s27
    s_mov_b64 exec, 1
    buffer_store_dwordx2 v[20:21], off, s[52:55], 0 sc1
    s_mov_b64 exec, -1
.Lnopub:
    v_and_b32 v124, 31, v0
    v_bfe_u32 v125, v0, 1, 3
    v_lshrrev_b32 v126, 5, v0
    v_xor_b32 v125, v125, v126
    v_lshlrev_b32 v124, 7, v124
    v_lshl_add_u32 v124, v125, 4, v124
    s_lshl_b32 s65, s60, 12
    s_add_u32 s65, s65, 98304
    v_add_u32 v4, s65, v124
    s_lshl_b32 s65, s60, 5
    v_xor_b32 v4, s65, v4
    v_xor_b32 v5, 32, v4
    v_xor_b32 v6, 64, v4
    v_xor_b32 v7, 96, v4
    v_lshrrev_b32 v124, 5, v0
    v_lshlrev_b32 v124, 3, v124
    v_bfe_u32 v125, v0, 2, 2
    v_add_u32 v124, v124, v125
    v_bfe_u32 v125, v0, 4, 1
    v_lshlrev_b32 v125, 5, v125
    v_and_b32 v126, 3, v0
    v_lshl_add_u32 v125, v126, 3, v125
    v_bfe_u32 v126, v0, 3, 1
    v_xor_b32 v126, s56, v126
    v_lshl_add_u32 v126, v126, 6, v125
    v_lshl_add_u32 v8, v124, 7, v126
    s_lshl_b32 s65, s60, 11
    v_add_u32 v8, s65, v8
    v_xor_b32 v9, 2048, v8
    v_xor_b32 v10, 4096, v8
    v_xor_b32 v11, 6144, v8
    v_and_b32 v124, 15, v0
    v_bfe_u32 v125, v0, 1, 3
    v_lshrrev_b32 v126, 4, v0
    v_xor_b32 v125, v125, v126
    v_lshlrev_b32 v124, 7, v124
    v_lshl_add_u32 v124, v125, 4, v124
    s_lshl_b32 s65, s3, 11
    s_add_u32 s65, s65, 98304
    v_add_u32 v14, s65, v124
    v_xor_b32 v15, 64, v14
    v_lshrrev_b32 v124, 4, v0
    v_xor_b32 v124, v124, v0
    v_and_b32 v124, 1, v124
    v_cmp_eq_u32 vcc, 0, v124
    v_mov_b32 v22, 0x3f803f80
    v_mov_b32 v36, 0x3f803f80
    v_mov_b32 v37, 0x3f803f80
    v_mov_b32 v38, 0x3f803f80
    v_mov_b32 v39, 0x3f803f80
    v_cndmask_b32 v16, 0, v22, vcc
    v_cndmask_b32 v17, 0, v22, vcc
    v_cndmask_b32 v18, 0, v22, vcc
    v_cndmask_b32 v19, 0, v22, vcc
    v_lshlrev_b32 v23, 4, v0
    s_lshl_b32 s65, s60, 2
    s_add_u32 s65, s65, 159744
    v_mov_b32 v124, s65
    v_mov_b32 v125, 1
    ds_write_b32 v124, v125
    s_mov_b32 s36, s24
    s_and_b32 s37, s25, 0xffff
    s_mov_b32 s38, 9437184
    s_mov_b32 s39, 0x00020000
    s_lshl_b32 s68, s58, 2
    s_add_u32 s68, s68, s60
    s_mul_i32 s68, s68, 147456
    s_lshl_b32 s65, s59, 12
    s_add_u32 s68, s68, s65
    s_lshl_b32 s65, s56, 11
    s_add_u32 s68, s68, s65
    s_add_u32 s68, s68, 114688
    s_mov_b32 s12, s16
    s_and_b32 s13, s17, 0xffff
    s_mov_b32 s14, 1835008
    s_mov_b32 s15, 0x00020000
    s_mov_b32 s4, s8
    s_and_b32 s5, s9, 0xffff
    s_mov_b32 s6, 524288
    s_mov_b32 s7, 0x00020000
    v_and_b32 v13, 7, v0
    v_lshlrev_b32 v13, 7, v13
    s_lshr_b32 s76, s2, 3
    s_lshl_b32 s76, s76, 10
    v_add_u32 v13, s76, v13
    s_and_b32 s77, s3, 1
    s_lshl_b32 s77, s77, 15
    s_mul_i32 s27, s3, 229376
    s_setprio 1
    s_add_u32 m0, s62, 131072
    s_add_u32 s70, s40, 256
    buffer_load_dwordx4 v1, s[28:31], s70 offen lds
    s_add_u32 m0, s62, 139264
    s_add_u32 s70, s40, 65792
    buffer_load_dwordx4 v1, s[28:31], s70 offen lds
    s_add_u32 m0, s62, 16384
    s_add_u32 s70, s42, 394240
    buffer_load_dwordx4 v2, s[32:35], s70 offen lds
    s_setprio 3
    s_waitcnt vmcnt(6)
    s_barrier
    ds_read_b128 v[128:131], v4 offset:0
    ds_read_b64_tr_b16 v[60:61], v8 offset:0
    ds_read_b64_tr_b16 v[62:63], v8 offset:512
    ds_read_b128 v[132:135], v5 offset:0
    ds_read_b64_tr_b16 v[64:65], v9 offset:0
    ds_read_b64_tr_b16 v[66:67], v9 offset:512
    ds_read_b128 v[136:139], v6 offset:0
    ds_read_b64_tr_b16 v[68:69], v10 offset:0
    ds_read_b64_tr_b16 v[70:71], v10 offset:512
    ds_read_b128 v[140:143], v7 offset:0
    ds_read_b64_tr_b16 v[72:73], v11 offset:0
    ds_read_b64_tr_b16 v[74:75], v11 offset:512
    ds_read_b128 v[100:103], v14 offset:0
    ds_read_b128 v[104:107], v15 offset:0
    s_waitcnt vmcnt(3) lgkmcnt(0)
    s_barrier
    v_mfma_f32_32x32x16_bf16 v[44:59], v[128:131], v[60:63], 0
    ds_read_b128 v[144:147], v4 offset:16384
    ds_read_b64_tr_b16 v[80:81], v8 offset:8192
    v_mfma_f32_16x16x32_bf16 v[28:31], v[100:103], v[100:103], 0
    ds_read_b64_tr_b16 v[82:83], v8 offset:8704
    ds_read_b128 v[148:151], v5 offset:16384
    s_add_u32 m0, s62, 65536
    s_add_u32 s70, s40, 384
    buffer_load_dwordx4 v1, s[28:31], s70 offen lds
    v_mfma_f32_32x32x16_bf16 v[44:59], v[132:135], v[64:67], v[44:59]
    ds_read_b64_tr_b16 v[84:85], v9 offset:8192
    ds_read_b64_tr_b16 v[86:87], v9 offset:8704
    v_mfma_f32_16x16x32_bf16 v[32:35], v[100:103], v[36:39], 0
    ds_read_b128 v[152:155], v6 offset:16384
    s_add_u32 m0, s62, 73728
    s_add_u32 s70, s40, 65920
    buffer_load_dwordx4 v1, s[28:31], s70 offen lds
    ds_read_b64_tr_b16 v[88:89], v10 offset:8192
    v_mfma_f32_16x16x32_bf16 v[28:31], v[104:107], v[104:107], v[28:31]
    ds_read_b64_tr_b16 v[90:91], v10 offset:8704
    ds_read_b128 v[156:159], v7 offset:16384
    v_mfma_f32_32x32x16_bf16 v[44:59], v[136:139], v[68:71], v[44:59]
    ds_read_b64_tr_b16 v[92:93], v11 offset:8192
    s_add_u32 m0, s62, 24576
    s_add_u32 s70, s42, 590848
    buffer_load_dwordx4 v2, s[32:35], s70 offen lds
    ds_read_b64_tr_b16 v[94:95], v11 offset:8704
    v_mfma_f32_16x16x32_bf16 v[32:35], v[104:107], v[36:39], v[32:35]
    ds_read_b128 v[108:111], v14 offset:16384
    ds_read_b128 v[112:115], v15 offset:16384
    s_add_u32 m0, s62, 81920
    s_add_u32 s70, s41, 512
    buffer_load_dwordx4 v1, s[28:31], s70 offen lds
    v_mfma_f32_32x32x16_bf16 v[44:59], v[140:143], v[72:75], v[44:59]
    v_mfma_f32_16x16x32_bf16 v[24:27], v[60:63], v[16:19], 0
    s_waitcnt vmcnt(4) lgkmcnt(0)
    s_barrier
    v_mfma_f32_32x32x16_bf16 v[44:59], v[144:147], v[80:83], v[44:59]
    ds_read_b128 v[160:163], v4 offset:32768
    ds_read_b64_tr_b16 v[60:61], v8 offset:16384
    v_mfma_f32_16x16x32_bf16 v[28:31], v[108:111], v[108:111], v[28:31]
    ds_read_b64_tr_b16 v[62:63], v8 offset:16896
    ds_read_b128 v[164:167], v5 offset:32768
    s_add_u32 m0, s62, 90112
    s_add_u32 s70, s41, 66048
    buffer_load_dwordx4 v1, s[28:31], s70 offen lds
    v_mfma_f32_32x32x16_bf16 v[44:59], v[148:151], v[84:87], v[44:59]
    ds_read_b64_tr_b16 v[64:65], v9 offset:16384
    ds_read_b64_tr_b16 v[66:67], v9 offset:16896
    v_mfma_f32_16x16x32_bf16 v[32:35], v[108:111], v[36:39], v[32:35]
    ds_read_b128 v[168:171], v6 offset:32768
    s_add_u32 m0, s62, 32768
    s_add_u32 s70, s43, 787456
    buffer_load_dwordx4 v2, s[32:35], s70 offen lds
    ds_read_b64_tr_b16 v[68:69], v10 offset:16384
    v_mfma_f32_16x16x32_bf16 v[28:31], v[112:115], v[112:115], v[28:31]
    ds_read_b64_tr_b16 v[70:71], v10 offset:16896
    ds_read_b128 v[172:175], v7 offset:32768
    v_mfma_f32_32x32x16_bf16 v[44:59], v[152:155], v[88:91], v[44:59]
    ds_read_b64_tr_b16 v[72:73], v11 offset:16384
    s_add_u32 m0, s62, 98304
    s_add_u32 s70, s41, 640
    buffer_load_dwordx4 v1, s[28:31], s70 offen lds
    ds_read_b64_tr_b16 v[74:75], v11 offset:16896
    v_mfma_f32_16x16x32_bf16 v[32:35], v[112:115], v[36:39], v[32:35]
    ds_read_b128 v[100:103], v14 offset:32768
    ds_read_b128 v[104:107], v15 offset:32768
    s_add_u32 m0, s62, 106496
    s_add_u32 s70, s41, 66176
    buffer_load_dwordx4 v1, s[28:31], s70 offen lds
    v_mfma_f32_32x32x16_bf16 v[44:59], v[156:159], v[92:95], v[44:59]
    v_mfma_f32_16x16x32_bf16 v[24:27], v[80:83], v[16:19], v[24:27]
    s_waitcnt vmcnt(5) lgkmcnt(0)
    s_barrier
    v_mfma_f32_32x32x16_bf16 v[44:59], v[160:163], v[60:63], v[44:59]
    v_subrev_u32 v4, 0x8000, v4
    v_subrev_u32 v5, 0x8000, v5
    v_subrev_u32 v6, 0x8000, v6
    v_mfma_f32_16x16x32_bf16 v[28:31], v[100:103], v[100:103], v[28:31]
    v_subrev_u32 v7, 0x8000, v7
    v_subrev_u32 v14, 0x8000, v14
    s_add_u32 m0, s62, 40960
    s_add_u32 s70, s43, 984064
    buffer_load_dwordx4 v2, s[32:35], s70 offen lds
    v_mfma_f32_32x32x16_bf16 v[44:59], v[164:167], v[64:67], v[44:59]
    v_subrev_u32 v15, 0x8000, v15
    ds_read_b128 v[176:179], v4 offset:0
    ds_read_b64_tr_b16 v[80:81], v8 offset:24576
    ds_read_b64_tr_b16 v[82:83], v8 offset:25088
    v_mfma_f32_16x16x32_bf16 v[32:35], v[100:103], v[36:39], v[32:35]
    ds_read_b128 v[180:183], v5 offset:0
    s_add_u32 m0, s62, 114688
    s_add_u32 s70, s41, 768
    buffer_load_dwordx4 v1, s[28:31], s70 offen lds
    ds_read_b64_tr_b16 v[84:85], v9 offset:24576
    v_mfma_f32_16x16x32_bf16 v[28:31], v[104:107], v[104:107], v[28:31]
    ds_read_b64_tr_b16 v[86:87], v9 offset:25088
    ds_read_b128 v[184:187], v6 offset:0
    ds_read_b64_tr_b16 v[88:89], v10 offset:24576
    ds_read_b64_tr_b16 v[90:91], v10 offset:25088
    v_mfma_f32_32x32x16_bf16 v[44:59], v[168:171], v[68:71], v[44:59]
    s_add_u32 m0, s62, 122880
    s_add_u32 s70, s41, 66304
    buffer_load_dwordx4 v1, s[28:31], s70 offen lds
    ds_read_b128 v[188:191], v7 offset:0
    ds_read_b64_tr_b16 v[92:93], v11 offset:24576
    v_mfma_f32_16x16x32_bf16 v[32:35], v[104:107], v[36:39], v[32:35]
    ds_read_b64_tr_b16 v[94:95], v11 offset:25088
    ds_read_b128 v[108:111], v14 offset:0
    ds_read_b128 v[112:115], v15 offset:0
    s_add_u32 m0, s62, 49152
    s_add_u32 s70, s43, 1180672
    buffer_load_dwordx4 v2, s[32:35], s70 offen lds
    v_mfma_f32_32x32x16_bf16 v[44:59], v[172:175], v[72:75], v[44:59]
    v_mfma_f32_16x16x32_bf16 v[24:27], v[60:63], v[16:19], v[24:27]
    s_waitcnt vmcnt(6) lgkmcnt(0)
    s_barrier
    v_mfma_f32_32x32x16_bf16 v[44:59], v[176:179], v[80:83], v[44:59]
    ds_read_b128 v[192:195], v4 offset:16384
    ds_read_b64_tr_b16 v[60:61], v8 offset:32768
    v_mfma_f32_16x16x32_bf16 v[28:31], v[108:111], v[108:111], v[28:31]
    ds_read_b64_tr_b16 v[62:63], v8 offset:33280
    ds_read_b128 v[196:199], v5 offset:16384
    s_add_u32 m0, s62, 131072
    s_add_u32 s70, s41, 896
    buffer_load_dwordx4 v1, s[28:31], s70 offen lds
    v_mfma_f32_32x32x16_bf16 v[44:59], v[180:183], v[84:87], v[44:59]
    ds_read_b64_tr_b16 v[64:65], v9 offset:32768
    ds_read_b64_tr_b16 v[66:67], v9 offset:33280
    v_mfma_f32_16x16x32_bf16 v[32:35], v[108:111], v[36:39], v[32:35]
    ds_read_b128 v[200:203], v6 offset:16384
    s_add_u32 m0, s62, 139264
    s_add_u32 s70, s41, 66432
    buffer_load_dwordx4 v1, s[28:31], s70 offen lds
    ds_read_b64_tr_b16 v[68:69], v10 offset:32768
    v_mfma_f32_16x16x32_bf16 v[28:31], v[112:115], v[112:115], v[28:31]
    ds_read_b64_tr_b16 v[70:71], v10 offset:33280
    ds_read_b128 v[204:207], v7 offset:16384
    v_mfma_f32_32x32x16_bf16 v[44:59], v[184:187], v[88:91], v[44:59]
    ds_read_b64_tr_b16 v[72:73], v11 offset:32768
    s_add_u32 m0, s62, 57344
    s_add_u32 s70, s43, 1377280
    buffer_load_dwordx4 v2, s[32:35], s70 offen lds
    ds_read_b64_tr_b16 v[74:75], v11 offset:33280
    v_mfma_f32_16x16x32_bf16 v[32:35], v[112:115], v[36:39], v[32:35]
    ds_read_b128 v[100:103], v14 offset:16384
    ds_read_b128 v[104:107], v15 offset:16384
    s_add_u32 m0, s44, 0
    s_add_u32 s70, s48, s73
    buffer_load_dwordx4 v2, s[32:35], s70 offen lds
    v_mfma_f32_32x32x16_bf16 v[44:59], v[188:191], v[92:95], v[44:59]
    v_mfma_f32_16x16x32_bf16 v[24:27], v[80:83], v[16:19], v[24:27]
    s_waitcnt vmcnt(7) lgkmcnt(0)
    s_barrier
    v_mfma_f32_32x32x16_bf16 v[44:59], v[192:195], v[60:63], v[44:59]
    v_add_u32 v4, 0x8000, v4
    v_add_u32 v5, 0x8000, v5
    v_add_u32 v6, 0x8000, v6
    v_mfma_f32_16x16x32_bf16 v[28:31], v[100:103], v[100:103], v[28:31]
    v_add_u32 v7, 0x8000, v7
    v_add_u32 v14, 0x8000, v14
    s_add_u32 m0, s44, 65536
    s_add_u32 s70, s48, s73
    s_add_u32 s70, s70, 2048
    buffer_load_dwordx4 v2, s[32:35], s70 offen lds
    v_mfma_f32_32x32x16_bf16 v[44:59], v[196:199], v[64:67], v[44:59]
    v_add_u32 v15, 0x8000, v15
    ds_read_b128 v[208:211], v4 offset:0
    ds_read_b64_tr_b16 v[80:81], v8 offset:40960
    ds_read_b64_tr_b16 v[82:83], v8 offset:41472
    v_mfma_f32_16x16x32_bf16 v[32:35], v[100:103], v[36:39], v[32:35]
    ds_read_b128 v[212:215], v5 offset:0
    s_add_u32 m0, s45, 65536
    s_add_u32 s70, s49, s73
    s_add_u32 s70, s70, 2048
    buffer_load_dwordx4 v2, s[32:35], s70 offen lds
    ds_read_b64_tr_b16 v[84:85], v9 offset:40960
    v_mfma_f32_16x16x32_bf16 v[28:31], v[104:107], v[104:107], v[28:31]
    ds_read_b64_tr_b16 v[86:87], v9 offset:41472
    ds_read_b128 v[216:219], v6 offset:0
    ds_read_b64_tr_b16 v[88:89], v10 offset:40960
    ds_read_b64_tr_b16 v[90:91], v10 offset:41472
    v_mfma_f32_32x32x16_bf16 v[44:59], v[200:203], v[68:71], v[44:59]
    s_add_u32 m0, s46, 65536
    s_add_u32 s70, s50, s73
    s_add_u32 s70, s70, 2048
    buffer_load_dwordx4 v2, s[32:35], s70 offen lds
    ds_read_b128 v[220:223], v7 offset:0
    ds_read_b64_tr_b16 v[92:93], v11 offset:40960
    v_mfma_f32_16x16x32_bf16 v[32:35], v[104:107], v[36:39], v[32:35]
    ds_read_b64_tr_b16 v[94:95], v11 offset:41472
    ds_read_b128 v[108:111], v14 offset:0
    ds_read_b128 v[112:115], v15 offset:0
    s_add_u32 m0, s47, 65536
    s_add_u32 s70, s51, s73
    s_add_u32 s70, s70, 2048
    buffer_load_dwordx4 v2, s[32:35], s70 offen lds
    v_mfma_f32_32x32x16_bf16 v[44:59], v[204:207], v[72:75], v[44:59]
    v_mfma_f32_16x16x32_bf16 v[24:27], v[60:63], v[16:19], v[24:27]
    s_waitcnt vmcnt(8) lgkmcnt(0)
    s_barrier
    v_mfma_f32_32x32x16_bf16 v[44:59], v[208:211], v[80:83], v[44:59]
    ds_read_b128 v[224:227], v4 offset:16384
    ds_read_b64_tr_b16 v[60:61], v8 offset:49152
    v_mfma_f32_16x16x32_bf16 v[28:31], v[108:111], v[108:111], v[28:31]
    ds_read_b64_tr_b16 v[62:63], v8 offset:49664
    ds_read_b128 v[228:231], v5 offset:16384
    s_add_u32 m0, s45, 0
    s_add_u32 s70, s49, s73
    buffer_load_dwordx4 v2, s[32:35], s70 offen lds
    v_mfma_f32_32x32x16_bf16 v[44:59], v[212:215], v[84:87], v[44:59]
    ds_read_b64_tr_b16 v[64:65], v9 offset:49152
    ds_read_b64_tr_b16 v[66:67], v9 offset:49664
    v_mfma_f32_16x16x32_bf16 v[32:35], v[108:111], v[36:39], v[32:35]
    ds_read_b128 v[232:235], v6 offset:16384
    s_add_u32 m0, s46, 0
    s_add_u32 s70, s50, s73
    buffer_load_dwordx4 v2, s[32:35], s70 offen lds
    ds_read_b64_tr_b16 v[68:69], v10 offset:49152
    v_mfma_f32_16x16x32_bf16 v[28:31], v[112:115], v[112:115], v[28:31]
    ds_read_b64_tr_b16 v[70:71], v10 offset:49664
    ds_read_b128 v[236:239], v7 offset:16384
    v_mfma_f32_32x32x16_bf16 v[44:59], v[216:219], v[88:91], v[44:59]
    ds_read_b64_tr_b16 v[72:73], v11 offset:49152
    s_add_u32 m0, s47, 0
    s_add_u32 s70, s51, s73
    buffer_load_dwordx4 v2, s[32:35], s70 offen lds
    ds_read_b64_tr_b16 v[74:75], v11 offset:49664
    v_mfma_f32_16x16x32_bf16 v[32:35], v[112:115], v[36:39], v[32:35]
    ds_read_b128 v[100:103], v14 offset:16384
    ds_read_b128 v[104:107], v15 offset:16384
    v_mfma_f32_32x32x16_bf16 v[44:59], v[220:223], v[92:95], v[44:59]
    v_mfma_f32_16x16x32_bf16 v[24:27], v[80:83], v[16:19], v[24:27]
    s_waitcnt vmcnt(8) lgkmcnt(0)
    s_barrier
    v_mfma_f32_32x32x16_bf16 v[44:59], v[224:227], v[60:63], v[44:59]
    ds_read_b128 v[240:243], v4 offset:32768
    ds_read_b64_tr_b16 v[80:81], v8 offset:57344
    v_mfma_f32_16x16x32_bf16 v[28:31], v[100:103], v[100:103], v[28:31]
    ds_read_b64_tr_b16 v[82:83], v8 offset:57856
    ds_read_b128 v[244:247], v5 offset:32768
    s_add_u32 m0, s44, 98304
    s_add_u32 s70, s48, s74
    s_add_u32 s70, s70, 2048
    buffer_load_dwordx4 v2, s[32:35], s70 offen lds
    v_mfma_f32_32x32x16_bf16 v[44:59], v[228:231], v[64:67], v[44:59]
    ds_read_b64_tr_b16 v[84:85], v9 offset:57344
    ds_read_b64_tr_b16 v[86:87], v9 offset:57856
    v_mfma_f32_16x16x32_bf16 v[32:35], v[100:103], v[36:39], v[32:35]
    ds_read_b128 v[248:251], v6 offset:32768
    s_add_u32 m0, s45, 98304
    s_add_u32 s70, s49, s74
    s_add_u32 s70, s70, 2048
    buffer_load_dwordx4 v2, s[32:35], s70 offen lds
    ds_read_b64_tr_b16 v[88:89], v10 offset:57344
    v_mfma_f32_16x16x32_bf16 v[28:31], v[104:107], v[104:107], v[28:31]
    ds_read_b64_tr_b16 v[90:91], v10 offset:57856
    ds_read_b128 v[252:255], v7 offset:32768
    v_mfma_f32_32x32x16_bf16 v[44:59], v[232:235], v[68:71], v[44:59]
    ds_read_b64_tr_b16 v[92:93], v11 offset:57344
    s_add_u32 m0, s46, 98304
    s_add_u32 s70, s50, s74
    s_add_u32 s70, s70, 2048
    buffer_load_dwordx4 v2, s[32:35], s70 offen lds
    ds_read_b64_tr_b16 v[94:95], v11 offset:57856
    v_mfma_f32_16x16x32_bf16 v[32:35], v[104:107], v[36:39], v[32:35]
    ds_read_b128 v[108:111], v14 offset:32768
    ds_read_b128 v[112:115], v15 offset:32768
    s_add_u32 m0, s47, 98304
    s_add_u32 s70, s51, s74
    s_add_u32 s70, s70, 2048
    buffer_load_dwordx4 v2, s[32:35], s70 offen lds
    v_mfma_f32_32x32x16_bf16 v[44:59], v[236:239], v[72:75], v[44:59]
    v_mfma_f32_16x16x32_bf16 v[24:27], v[60:63], v[16:19], v[24:27]
    s_waitcnt lgkmcnt(0)
    s_barrier
    v_mfma_f32_32x32x16_bf16 v[44:59], v[240:243], v[80:83], v[44:59]
    v_mfma_f32_16x16x32_bf16 v[28:31], v[108:111], v[108:111], v[28:31]
    s_add_u32 m0, s44, 32768
    s_add_u32 s70, s48, s74
    buffer_load_dwordx4 v2, s[32:35], s70 offen lds
    v_mfma_f32_32x32x16_bf16 v[44:59], v[244:247], v[84:87], v[44:59]
    v_mfma_f32_16x16x32_bf16 v[32:35], v[108:111], v[36:39], v[32:35]
    s_add_u32 m0, s45, 32768
    s_add_u32 s70, s49, s74
    buffer_load_dwordx4 v2, s[32:35], s70 offen lds
    v_mfma_f32_16x16x32_bf16 v[28:31], v[112:115], v[112:115], v[28:31]
    v_mfma_f32_32x32x16_bf16 v[44:59], v[248:251], v[88:91], v[44:59]
    s_add_u32 m0, s46, 32768
    s_add_u32 s70, s50, s74
    buffer_load_dwordx4 v2, s[32:35], s70 offen lds
    v_mfma_f32_16x16x32_bf16 v[32:35], v[112:115], v[36:39], v[32:35]
    s_add_u32 m0, s47, 32768
    s_add_u32 s70, s51, s74
    buffer_load_dwordx4 v2, s[32:35], s70 offen lds
    v_mfma_f32_32x32x16_bf16 v[44:59], v[252:255], v[92:95], v[44:59]
    v_mfma_f32_16x16x32_bf16 v[24:27], v[80:83], v[16:19], v[24:27]
    v_and_b32 v126, 15, v0
    v_lshlrev_b32 v126, 6, v126
    v_lshrrev_b32 v127, 4, v0
    v_lshl_add_u32 v126, v127, 4, v126
    s_add_u32 s65, s62, 147456
    v_add_u32 v126, s65, v126
    s_lshl_b32 s65, s3, 6
    s_add_u32 s65, s65, 155648
    v_lshl_add_u32 v127, v127, 4, s65
    ds_write_b128 v126, v[28:31]
    ds_write_b128 v127, v[32:35]
    v_and_b32 v124, 1, v0
    v_lshlrev_b32 v124, 6, v124
    v_lshrrev_b32 v125, 4, v0
    v_lshl_add_u32 v124, v125, 4, v124
    s_lshl_b32 s65, s3, 7
    s_add_u32 s65, s65, 156160
    v_add_u32 v124, s65, v124
    s_nop 1
    ds_write_b128 v124, v[24:27]
    v_xor_b32 v8, 0x10000, v8
    v_xor_b32 v9, 0x10000, v9
    v_xor_b32 v10, 0x10000, v10
    v_xor_b32 v11, 0x10000, v11
    s_waitcnt vmcnt(11) lgkmcnt(0)
    s_barrier
    ds_read_b64_tr_b16 v[76:77], v8 offset:0
    ds_read_b64_tr_b16 v[78:79], v8 offset:512
    ds_read_b64_tr_b16 v[80:81], v9 offset:0
    ds_read_b64_tr_b16 v[82:83], v9 offset:512
    ds_read_b64_tr_b16 v[84:85], v10 offset:0
    ds_read_b64_tr_b16 v[86:87], v10 offset:512
    ds_read_b64_tr_b16 v[88:89], v11 offset:0
    ds_read_b64_tr_b16 v[90:91], v11 offset:512
    s_waitcnt lgkmcnt(6)
    v_mfma_f32_32x32x16_bf16 v[60:75], v[128:131], v[76:79], 0
    v_mfma_f32_16x16x32_bf16 v[24:27], v[76:79], v[16:19], 0
    ds_read_b64_tr_b16 v[92:93], v8 offset:8192
    ds_read_b64_tr_b16 v[94:95], v8 offset:8704
    v_and_b32 v124, 31, v0
    v_lshlrev_b32 v125, 6, v124
    v_and_b32 v127, 15, v0
    v_lshl_add_u32 v125, v127, 2, v125
    s_lshl_b32 s65, s60, 11
    s_waitcnt lgkmcnt(6)
    v_mfma_f32_32x32x16_bf16 v[60:75], v[132:135], v[80:83], v[60:75]
    ds_read_b64_tr_b16 v[76:77], v9 offset:8192
    ds_read_b64_tr_b16 v[78:79], v9 offset:8704
    s_add_u32 s65, s65, 147456
    v_add_u32 v125, s65, v125
    s_lshl_b32 s65, s60, 7
    s_add_u32 s65, s65, 155648
    v_lshl_add_u32 v127, v124, 2, s65
    s_mov_b32 s52, s22
    s_and_b32 s53, s23, 0xffff
    s_mov_b32 s54, 256
    s_mov_b32 s55, 0x00020000
    buffer_load_dwordx2 v[20:21], off, s[52:55], 0 sc1
    s_waitcnt lgkmcnt(6)
    v_mfma_f32_32x32x16_bf16 v[60:75], v[136:139], v[84:87], v[60:75]
    ds_read_b64_tr_b16 v[80:81], v10 offset:8192
    ds_read_b64_tr_b16 v[82:83], v10 offset:8704
    ds_read_b32 v101, v125
    ds_read_b32 v100, v127
    s_waitcnt lgkmcnt(0)
    v_mul_f32 v100, 0xbb000000, v100
    v_mul_f32 v101, 0x3b000000, v101
    v_mfma_f32_32x32x16_bf16 v[60:75], v[140:143], v[88:91], v[60:75]
    ds_read_b64_tr_b16 v[84:85], v11 offset:8192
    ds_read_b64_tr_b16 v[86:87], v11 offset:8704
    v_fma_f32 v101, -v100, v100, v101
    v_max_f32 v101, 0, v101
    v_add_f32 v101, 0x3727c5ac, v101
    v_rsq_f32 v36, v101
    v_sqrt_f32 v37, v101
    v_lshrrev_b32 v14, 3, v0
    v_lshlrev_b32 v14, 10, v14
    v_and_b32 v15, 7, v0
    v_lshrrev_b32 v2, 2, v0
    v_and_b32 v2, 4, v2
    v_xor_b32 v15, v15, v2
    v_lshl_add_u32 v2, v15, 4, v14
    s_bfe_u32 s70, s2, 0x30003
    s_and_b32 s26, s3, 1
    s_lshl_b32 s26, s26, 15
    s_lshl_b32 s70, s70, 7
    s_mul_i32 s75, s3, 229376
    s_add_u32 s70, s70, s75
    v_add_u32 v2, s70, v2
    s_lshl_b32 s17, s3, 11
    v_mfma_f32_32x32x16_bf16 v[60:75], v[144:147], v[92:95], v[60:75]
    v_mfma_f32_16x16x32_bf16 v[24:27], v[92:95], v[16:19], v[24:27]
    ds_read_b64_tr_b16 v[88:89], v8 offset:16384
    ds_read_b64_tr_b16 v[90:91], v8 offset:16896
    v_cvt_pk_bf16_f32 v104, v100, v100
    v_and_b32 v104, 0xffff0000, v104
    v_sub_f32 v105, v100, v104
    v_cvt_pk_bf16_f32 v28, v104, v105
    v_mov_b32 v29, v28
    v_cvt_pk_bf16_f32 v104, v37, v37
    v_mfma_f32_32x32x16_bf16 v[60:75], v[148:151], v[76:79], v[60:75]
    ds_read_b64_tr_b16 v[92:93], v9 offset:16384
    ds_read_b64_tr_b16 v[94:95], v9 offset:16896
    v_and_b32 v104, 0xffff0000, v104
    v_sub_f32 v105, v37, v104
    v_cvt_pk_bf16_f32 v30, v104, v105
    v_mov_b32 v31, 0
    s_mov_b32 m0, 160256
    s_add_u32 s70, s77, s27
    buffer_load_dword v13, s[12:15], s70 offen lds
    s_add_u32 s77, s77, 32768
    s_cmp_eq_u32 s77, 229376
    s_cselect_b32 s77, 0, s77
    v_mfma_f32_32x32x16_bf16 v[60:75], v[152:155], v[80:83], v[60:75]
    ds_read_b64_tr_b16 v[76:77], v10 offset:16384
    ds_read_b64_tr_b16 v[78:79], v10 offset:16896
    v_mov_b32 v35, 0
    v_mov_b32 v34, 0
    v_mov_b32 v38, 0x358637bd
    v_mul_f32 v39, 0x3fb8aa3b, v36
    s_lshl_b32 s65, s3, 7
    s_add_u32 s65, s65, 158208
    s_waitcnt lgkmcnt(6)
    v_mfma_f32_32x32x16_bf16 v[60:75], v[156:159], v[84:87], v[60:75]
    ds_read_b64_tr_b16 v[80:81], v11 offset:16384
    ds_read_b64_tr_b16 v[82:83], v11 offset:16896
    v_lshl_add_u32 v125, v124, 2, s65
    ds_write_b32 v125, v36
    v_lshrrev_b32 v125, 5, v0
    v_lshl_add_u32 v125, v125, 4, s65
    s_mov_b32 m0, 160256
    s_add_u32 s70, s77, s27
    buffer_load_dword v13, s[12:15], s70 offen lds
    s_add_u32 s77, s77, 32768
    s_cmp_eq_u32 s77, 229376
    s_cselect_b32 s77, 0, s77
    s_waitcnt lgkmcnt(7)
    v_mfma_f32_32x32x16_bf16 v[60:75], v[160:163], v[88:91], v[60:75]
    v_mfma_f32_16x16x32_bf16 v[24:27], v[88:91], v[16:19], v[24:27]
    ds_read_b64_tr_b16 v[84:85], v8 offset:24576
    ds_read_b64_tr_b16 v[86:87], v8 offset:25088
    s_waitcnt lgkmcnt(2)
    ds_read_b128 v[100:103], v125 offset:0
    ds_read_b128 v[104:107], v125 offset:32
    ds_read_b128 v[108:111], v125 offset:64
    ds_read_b128 v[112:115], v125 offset:96
    v_and_b32 v126, 31, v0
    v_mfma_f32_32x32x16_bf16 v[60:75], v[164:167], v[92:95], v[60:75]
    ds_read_b64_tr_b16 v[88:89], v9 offset:24576
    ds_read_b64_tr_b16 v[90:91], v9 offset:25088
    s_lshl_b32 s65, s56, 9
    s_add_u32 s65, s65, 156160
    v_lshl_add_u32 v126, v126, 2, s65
    ds_read_b32 v116, v126 offset:0
    s_mov_b32 m0, 160256
    s_add_u32 s70, s77, s27
    buffer_load_dword v13, s[12:15], s70 offen lds
    s_add_u32 s77, s77, 32768
    s_cmp_eq_u32 s77, 229376
    s_cselect_b32 s77, 0, s77
    ds_read_b32 v117, v126 offset:128
    v_mfma_f32_32x32x16_bf16 v[60:75], v[168:171], v[76:79], v[60:75]
    ds_read_b64_tr_b16 v[92:93], v10 offset:24576
    ds_read_b64_tr_b16 v[94:95], v10 offset:25088
    ds_read_b32 v118, v126 offset:256
    ds_read_b32 v119, v126 offset:384
    v_cmp_gt_u32 vcc, 32, v0
    s_waitcnt lgkmcnt(0)
    v_add_f32 v116, v116, v117
    v_mfma_f32_32x32x16_bf16 v[60:75], v[172:175], v[80:83], v[60:75]
    ds_read_b64_tr_b16 v[76:77], v11 offset:24576
    ds_read_b64_tr_b16 v[78:79], v11 offset:25088
    v_add_f32 v118, v118, v119
    v_add_f32 v116, v116, v118
    v_cvt_pk_bf16_f32 v32, v116, v116
    v_and_b32 v117, 0xffff0000, v32
    s_mov_b32 m0, 160256
    s_add_u32 s70, s77, s27
    buffer_load_dword v13, s[12:15], s70 offen lds
    s_add_u32 s77, s77, 32768
    s_cmp_eq_u32 s77, 229376
    s_cselect_b32 s77, 0, s77
    v_sub_f32 v117, v116, v117
    s_waitcnt vmcnt(9)
    s_barrier
    v_mfma_f32_32x32x16_bf16 v[60:75], v[176:179], v[84:87], v[60:75]
    v_mfma_f32_16x16x32_bf16 v[24:27], v[84:87], v[16:19], v[24:27]
    ds_read_b64_tr_b16 v[80:81], v8 offset:32768
    ds_read_b64_tr_b16 v[82:83], v8 offset:33280
    v_cvt_pk_bf16_f32 v33, v117, v117
    v_cndmask_b32 v32, 0, v32, vcc
    v_cndmask_b32 v33, 0, v33, vcc
    s_nop 1
    v_mfma_f32_32x32x16_bf16 v[44:59], v[28:31], v[32:35], v[44:59]
    v_mfma_f32_32x32x16_bf16 v[60:75], v[180:183], v[88:91], v[60:75]
    ds_read_b64_tr_b16 v[84:85], v9 offset:32768
    ds_read_b64_tr_b16 v[86:87], v9 offset:33280
    s_nop 7
    s_nop 7
    v_fma_f32 v44, v44, v100, v38
    s_mov_b32 m0, 160256
    s_add_u32 s70, s77, s27
    buffer_load_dword v13, s[12:15], s70 offen lds
    s_add_u32 s77, s77, 32768
    s_cmp_eq_u32 s77, 229376
    s_cselect_b32 s77, 0, s77
    v_fma_f32 v45, v45, v101, v38
    v_mfma_f32_32x32x16_bf16 v[60:75], v[184:187], v[92:95], v[60:75]
    ds_read_b64_tr_b16 v[88:89], v10 offset:32768
    ds_read_b64_tr_b16 v[90:91], v10 offset:33280
    v_fma_f32 v46, v46, v102, v38
    v_fma_f32 v47, v47, v103, v38
    v_fma_f32 v48, v48, v104, v38
    v_fma_f32 v49, v49, v105, v38
    v_fma_f32 v50, v50, v106, v38
    v_fma_f32 v51, v51, v107, v38
    s_waitcnt lgkmcnt(6)
    v_mfma_f32_32x32x16_bf16 v[60:75], v[188:191], v[76:79], v[60:75]
    ds_read_b64_tr_b16 v[92:93], v11 offset:32768
    ds_read_b64_tr_b16 v[94:95], v11 offset:33280
    v_mul_f32 v116, 0x3fb8aa3b, v44
    v_mul_f32 v117, 0x3fb8aa3b, v45
    v_mul_f32 v118, 0x3fb8aa3b, v46
    s_mov_b32 m0, 160256
    s_add_u32 s70, s77, s27
    buffer_load_dword v13, s[12:15], s70 offen lds
    s_add_u32 s77, s77, 32768
    s_cmp_eq_u32 s77, 229376
    s_cselect_b32 s77, 0, s77
    v_mul_f32 v119, 0x3fb8aa3b, v47
    s_waitcnt lgkmcnt(6)
    v_mfma_f32_32x32x16_bf16 v[60:75], v[192:195], v[80:83], v[60:75]
    v_mfma_f32_16x16x32_bf16 v[24:27], v[80:83], v[16:19], v[24:27]
    ds_read_b64_tr_b16 v[76:77], v8 offset:40960
    ds_read_b64_tr_b16 v[78:79], v8 offset:41472
    v_mul_f32 v120, 0x3fb8aa3b, v48
    v_mul_f32 v121, 0x3fb8aa3b, v49
    v_mul_f32 v122, 0x3fb8aa3b, v50
    v_mul_f32 v123, 0x3fb8aa3b, v51
    v_exp_f32 v116, v116 clamp
    v_exp_f32 v117, v117 clamp
    s_waitcnt lgkmcnt(6)
    v_mfma_f32_32x32x16_bf16 v[60:75], v[196:199], v[84:87], v[60:75]
    ds_read_b64_tr_b16 v[80:81], v9 offset:40960
    ds_read_b64_tr_b16 v[82:83], v9 offset:41472
    v_exp_f32 v118, v118 clamp
    v_exp_f32 v119, v119 clamp
    v_exp_f32 v120, v120 clamp
    s_mov_b32 m0, 160256
    s_add_u32 s70, s77, s27
    buffer_load_dword v13, s[12:15], s70 offen lds
    s_add_u32 s77, s77, 32768
    s_cmp_eq_u32 s77, 229376
    s_cselect_b32 s77, 0, s77
    v_exp_f32 v121, v121 clamp
    s_waitcnt lgkmcnt(6)
    v_mfma_f32_32x32x16_bf16 v[60:75], v[200:203], v[88:91], v[60:75]
    ds_read_b64_tr_b16 v[84:85], v10 offset:40960
    ds_read_b64_tr_b16 v[86:87], v10 offset:41472
    v_exp_f32 v122, v122 clamp
    v_exp_f32 v123, v123 clamp
    v_max_f32 v44, v44, v38
    v_max_f32 v45, v45, v38
    v_max_f32 v46, v46, v38
    v_max_f32 v47, v47, v38
    s_waitcnt lgkmcnt(6)
    v_mfma_f32_32x32x16_bf16 v[60:75], v[204:207], v[92:95], v[60:75]
    ds_read_b64_tr_b16 v[88:89], v11 offset:40960
    ds_read_b64_tr_b16 v[90:91], v11 offset:41472
    v_max_f32 v48, v48, v38
    v_max_f32 v49, v49, v38
    v_max_f32 v50, v50, v38
    s_mov_b32 m0, 160256
    s_lshl_b32 s70, s3, 16
    s_add_u32 s70, s70, 0
    buffer_load_dword v13, s[4:7], s70 offen lds
    v_max_f32 v51, v51, v38
    v_add_f32 v44, v44, v116
    s_waitcnt lgkmcnt(6)
    v_mfma_f32_32x32x16_bf16 v[60:75], v[208:211], v[76:79], v[60:75]
    v_mfma_f32_16x16x32_bf16 v[24:27], v[76:79], v[16:19], v[24:27]
    ds_read_b64_tr_b16 v[92:93], v8 offset:49152
    ds_read_b64_tr_b16 v[94:95], v8 offset:49664
    v_add_f32 v45, v45, v117
    v_add_f32 v46, v46, v118
    v_add_f32 v47, v47, v119
    v_add_f32 v48, v48, v120
    v_add_f32 v49, v49, v121
    s_waitcnt lgkmcnt(6)
    v_mfma_f32_32x32x16_bf16 v[60:75], v[212:215], v[80:83], v[60:75]
    ds_read_b64_tr_b16 v[76:77], v9 offset:49152
    ds_read_b64_tr_b16 v[78:79], v9 offset:49664
    v_add_f32 v50, v50, v122
    v_add_f32 v51, v51, v123
    s_mov_b32 m0, 160256
    s_lshl_b32 s70, s3, 16
    s_add_u32 s70, s70, 32768
    buffer_load_dword v13, s[4:7], s70 offen lds
    v_cvt_pk_bf16_f32 v40, v44, v45
    v_cvt_pk_bf16_f32 v41, v46, v47
    v_cvt_pk_bf16_f32 v42, v48, v49
    s_waitcnt lgkmcnt(6)
    v_mfma_f32_32x32x16_bf16 v[60:75], v[216:219], v[84:87], v[60:75]
    ds_read_b64_tr_b16 v[80:81], v10 offset:49152
    ds_read_b64_tr_b16 v[82:83], v10 offset:49664
    v_cvt_pk_bf16_f32 v43, v50, v51
    v_fma_f32 v52, v52, v108, v38
    v_fma_f32 v53, v53, v109, v38
    v_fma_f32 v54, v54, v110, v38
    v_fma_f32 v55, v55, v111, v38
    s_waitcnt lgkmcnt(6)
    v_mfma_f32_32x32x16_bf16 v[60:75], v[220:223], v[88:91], v[60:75]
    ds_read_b64_tr_b16 v[84:85], v11 offset:49152
    ds_read_b64_tr_b16 v[86:87], v11 offset:49664
    v_fma_f32 v56, v56, v112, v38
    v_fma_f32 v57, v57, v113, v38
    v_fma_f32 v58, v58, v114, v38
    v_fma_f32 v59, v59, v115, v38
    v_mul_f32 v116, 0x3fb8aa3b, v52
    v_mul_f32 v117, 0x3fb8aa3b, v53
    s_waitcnt lgkmcnt(6)
    v_mfma_f32_32x32x16_bf16 v[60:75], v[224:227], v[92:95], v[60:75]
    v_mfma_f32_16x16x32_bf16 v[24:27], v[92:95], v[16:19], v[24:27]
    ds_read_b64_tr_b16 v[88:89], v8 offset:57344
    ds_read_b64_tr_b16 v[90:91], v8 offset:57856
    v_mul_f32 v118, 0x3fb8aa3b, v54
    v_mul_f32 v119, 0x3fb8aa3b, v55
    v_mul_f32 v120, 0x3fb8aa3b, v56
    v_mul_f32 v121, 0x3fb8aa3b, v57
    v_mul_f32 v122, 0x3fb8aa3b, v58
    v_mul_f32 v123, 0x3fb8aa3b, v59
    s_waitcnt lgkmcnt(6)
    v_mfma_f32_32x32x16_bf16 v[60:75], v[228:231], v[76:79], v[60:75]
    ds_read_b64_tr_b16 v[92:93], v9 offset:57344
    ds_read_b64_tr_b16 v[94:95], v9 offset:57856
    v_exp_f32 v116, v116 clamp
    v_exp_f32 v117, v117 clamp
    v_exp_f32 v118, v118 clamp
    v_exp_f32 v119, v119 clamp
    v_exp_f32 v120, v120 clamp
    s_waitcnt lgkmcnt(6)
    v_mfma_f32_32x32x16_bf16 v[60:75], v[232:235], v[80:83], v[60:75]
    ds_read_b64_tr_b16 v[76:77], v10 offset:57344
    ds_read_b64_tr_b16 v[78:79], v10 offset:57856
    v_exp_f32 v121, v121 clamp
    v_exp_f32 v122, v122 clamp
    v_exp_f32 v123, v123 clamp
    v_max_f32 v52, v52, v38
    v_max_f32 v53, v53, v38
    v_max_f32 v54, v54, v38
    s_waitcnt lgkmcnt(6)
    v_mfma_f32_32x32x16_bf16 v[60:75], v[236:239], v[84:87], v[60:75]
    ds_read_b64_tr_b16 v[80:81], v11 offset:57344
    ds_read_b64_tr_b16 v[82:83], v11 offset:57856
    v_max_f32 v55, v55, v38
    v_max_f32 v56, v56, v38
    v_max_f32 v57, v57, v38
    v_max_f32 v58, v58, v38
    v_max_f32 v59, v59, v38
    s_waitcnt lgkmcnt(6)
    v_mfma_f32_32x32x16_bf16 v[60:75], v[240:243], v[88:91], v[60:75]
    v_mfma_f32_16x16x32_bf16 v[24:27], v[88:91], v[16:19], v[24:27]
    v_add_f32 v52, v52, v116
    v_add_f32 v53, v53, v117
    v_add_f32 v54, v54, v118
    v_add_f32 v55, v55, v119
    v_add_f32 v56, v56, v120
    v_add_f32 v57, v57, v121
    s_waitcnt lgkmcnt(4)
    v_mfma_f32_32x32x16_bf16 v[60:75], v[244:247], v[92:95], v[60:75]
    v_add_f32 v58, v58, v122
    v_add_f32 v59, v59, v123
    v_cvt_pk_bf16_f32 v4, v52, v53
    v_cvt_pk_bf16_f32 v5, v54, v55
    v_cvt_pk_bf16_f32 v6, v56, v57
    v_cvt_pk_bf16_f32 v7, v58, v59
    s_waitcnt lgkmcnt(2)
    v_mfma_f32_32x32x16_bf16 v[60:75], v[248:251], v[76:79], v[60:75]
    s_waitcnt lgkmcnt(0)
    v_mfma_f32_32x32x16_bf16 v[60:75], v[252:255], v[80:83], v[60:75]
    v_and_b32 v124, 1, v0
    v_lshlrev_b32 v124, 6, v124
    v_lshrrev_b32 v125, 4, v0
    v_lshl_add_u32 v124, v125, 4, v124
    s_lshl_b32 s65, s3, 7
    s_add_u32 s65, s65, 157184
    v_add_u32 v124, s65, v124
    s_nop 1
    ds_write_b128 v124, v[24:27]
    v_xor_b32 v8, 0x10000, v8
    v_xor_b32 v9, 0x10000, v9
    v_xor_b32 v10, 0x10000, v10
    v_xor_b32 v11, 0x10000, v11
    s_waitcnt vmcnt(9) lgkmcnt(0)
    s_barrier
    v_cmp_eq_u32 vcc, 0, v21
    s_nop 1
    s_cbranch_vccz .Ltok0_ok
    s_mov_b32 s75, 32768
.Ltok0_lp:
    s_sleep 8
    buffer_load_dwordx2 v[20:21], off, s[52:55], 0 sc1
    s_waitcnt vmcnt(0)
    v_cmp_eq_u32 vcc, 0, v21
    s_nop 1
    s_cbranch_vccz .Ltok0_ok
    s_sub_u32 s75, s75, 1
    s_cmp_lg_u32 s75, 0
    s_cbranch_scc1 .Ltok0_lp
.Ltok0_ok:
    s_add_u32 s52, s24, 11010048
    s_addc_u32 s53, s25, 0
    s_and_b32 s53, s53, 0xffff
    s_mov_b32 s54, 131072
    s_mov_b32 s55, 0x00020000
    s_lshr_b32 s76, s60, 1
    s_lshl_b32 s76, s76, 3
    s_add_u32 s76, s76, s59
    s_lshl_b32 s76, s76, 8
    s_and_b32 s70, s60, 1
    s_lshl_b32 s70, s70, 4
    s_add_u32 s76, s76, s70
    s_lshl_b32 s70, s56, 3
    s_add_u32 s76, s76, s70
    s_lshl_b32 s70, s58, 12
    s_add_u32 s76, s76, s70
    ds_read_b64_tr_b16 v[76:77], v8 offset:0
    ds_read_b64_tr_b16 v[78:79], v8 offset:512
    ds_read_b64_tr_b16 v[80:81], v9 offset:0
    ds_read_b64_tr_b16 v[82:83], v9 offset:512
    ds_read_b64_tr_b16 v[84:85], v10 offset:0
    ds_read_b64_tr_b16 v[86:87], v10 offset:512
    ds_read_b64_tr_b16 v[88:89], v11 offset:0
    ds_read_b64_tr_b16 v[90:91], v11 offset:512
    s_waitcnt lgkmcnt(6)
    v_mfma_f32_32x32x16_bf16 v[44:59], v[76:79], v[128:131], 0
    v_mfma_f32_16x16x32_bf16 v[24:27], v[76:79], v[16:19], 0
    ds_read_b64_tr_b16 v[92:93], v8 offset:8192
    ds_read_b64_tr_b16 v[94:95], v8 offset:8704
    v_and_b32 v126, 31, v0
    s_lshl_b32 s65, s56, 9
    s_add_u32 s65, s65, 157184
    v_lshl_add_u32 v126, v126, 2, s65
    ds_read_b32 v116, v126 offset:0
    ds_read_b32 v117, v126 offset:128
    ds_read_b32 v118, v126 offset:256
    ds_read_b32 v119, v126 offset:384
    v_cmp_gt_u32 vcc, 32, v0
    s_waitcnt lgkmcnt(0)
    v_add_f32 v116, v116, v117
    v_add_f32 v118, v118, v119
    v_add_f32 v116, v116, v118
    v_cvt_pk_bf16_f32 v32, v116, v116
    v_and_b32 v117, 0xffff0000, v32
    v_sub_f32 v117, v116, v117
    v_mfma_f32_32x32x16_bf16 v[44:59], v[80:83], v[132:135], v[44:59]
    ds_read_b64_tr_b16 v[76:77], v9 offset:8192
    ds_read_b64_tr_b16 v[78:79], v9 offset:8704
    v_cvt_pk_bf16_f32 v33, v117, v117
    v_cndmask_b32 v32, 0, v32, vcc
    v_cndmask_b32 v33, 0, v33, vcc
    s_nop 1
    v_mfma_f32_32x32x16_bf16 v[60:75], v[28:31], v[32:35], v[60:75]
    s_nop 7
    s_nop 7
    v_mul_f32 v60, v60, v100
    v_mul_f32 v61, v61, v101
    v_mul_f32 v62, v62, v102
    v_mul_f32 v63, v63, v103
    v_mul_f32 v64, v64, v104
    v_mul_f32 v65, v65, v105
    v_mul_f32 v66, v66, v106
    v_mul_f32 v67, v67, v107
    v_mul_f32 v68, v68, v108
    v_mul_f32 v69, v69, v109
    v_mfma_f32_32x32x16_bf16 v[44:59], v[84:87], v[136:139], v[44:59]
    ds_read_b64_tr_b16 v[80:81], v10 offset:8192
    ds_read_b64_tr_b16 v[82:83], v10 offset:8704
    v_mul_f32 v70, v70, v110
    v_mul_f32 v71, v71, v111
    v_mul_f32 v72, v72, v112
    v_mul_f32 v73, v73, v113
    v_mul_f32 v74, v74, v114
    v_mul_f32 v75, v75, v115
    v_cvt_pk_bf16_f32 v116, v60, v61
    v_cvt_pk_bf16_f32 v117, v62, v63
    v_cvt_pk_bf16_f32 v118, v64, v65
    v_cvt_pk_bf16_f32 v119, v66, v67
    v_cvt_pk_bf16_f32 v120, v68, v69
    v_cvt_pk_bf16_f32 v121, v70, v71
    v_cvt_pk_bf16_f32 v122, v72, v73
    v_cvt_pk_bf16_f32 v123, v74, v75
    v_and_b32 v124, 16, v0
    v_cmp_eq_u32 s[66:67], 0, v124
    s_nop 1
    v_mfma_f32_32x32x16_bf16 v[44:59], v[88:91], v[140:143], v[44:59]
    ds_read_b64_tr_b16 v[84:85], v11 offset:8192
    ds_read_b64_tr_b16 v[86:87], v11 offset:8704
    v_cndmask_b32 v100, v22, v116, s[66:67]
    v_cndmask_b32 v108, v116, v22, s[66:67]
    v_cndmask_b32 v101, v22, v117, s[66:67]
    v_cndmask_b32 v109, v117, v22, s[66:67]
    v_cndmask_b32 v102, v22, v118, s[66:67]
    v_cndmask_b32 v110, v118, v22, s[66:67]
    v_cndmask_b32 v103, v22, v119, s[66:67]
    v_cndmask_b32 v111, v119, v22, s[66:67]
    v_cndmask_b32 v104, v22, v120, s[66:67]
    v_cndmask_b32 v112, v120, v22, s[66:67]
    v_cndmask_b32 v105, v22, v121, s[66:67]
    v_cndmask_b32 v113, v121, v22, s[66:67]
    v_cndmask_b32 v106, v22, v122, s[66:67]
    v_cndmask_b32 v114, v122, v22, s[66:67]
    v_cndmask_b32 v107, v22, v123, s[66:67]
    v_cndmask_b32 v115, v123, v22, s[66:67]
    s_nop 1
    v_mfma_f32_32x32x16_bf16 v[44:59], v[92:95], v[144:147], v[44:59]
    v_mfma_f32_16x16x32_bf16 v[24:27], v[92:95], v[16:19], v[24:27]
    ds_read_b64_tr_b16 v[88:89], v8 offset:16384
    ds_read_b64_tr_b16 v[90:91], v8 offset:16896
    s_lshl_b32 s65, s3, 12
    s_add_u32 s65, s65, 0x10000
    v_add_u32 v125, s65, v23
    v_mfma_f32_32x32x16_bf16 v[60:75], v[40:43], v[100:103], 0
    v_mfma_f32_32x32x16_bf16 v[60:75], v[4:7], v[104:107], v[60:75]
    s_nop 7
    s_nop 7
    ds_write_b128 v125, v[60:63] offset:0
    ds_write_b128 v125, v[64:67] offset:1024
    s_waitcnt lgkmcnt(0)
    v_mfma_f32_32x32x16_bf16 v[60:75], v[40:43], v[108:111], 0
    v_mfma_f32_32x32x16_bf16 v[60:75], v[4:7], v[112:115], v[60:75]
    s_nop 7
    s_nop 7
    ds_write_b128 v125, v[68:71] offset:2048
    ds_write_b128 v125, v[72:75] offset:3072
    s_waitcnt lgkmcnt(0)
    v_mfma_f32_32x32x16_bf16 v[44:59], v[76:79], v[148:151], v[44:59]
    ds_read_b64_tr_b16 v[92:93], v9 offset:16384
    ds_read_b64_tr_b16 v[94:95], v9 offset:16896
    s_barrier
    s_lshl_b32 s65, s60, 10
    s_lshl_b32 s66, s56, 14
    s_add_u32 s65, s65, s66
    s_add_u32 s65, s65, 0x10000
    v_add_u32 v125, s65, v23
    ds_read_b128 v[60:63], v125 offset:0
    ds_read_b128 v[64:67], v125 offset:4096
    ds_read_b128 v[68:71], v125 offset:8192
    ds_read_b128 v[72:75], v125 offset:12288
    s_add_u32 s48, s24, 9437184
    s_addc_u32 s49, s25, 0
    s_and_b32 s49, s49, 0xffff
    s_mov_b32 s50, 1048576
    s_mov_b32 s51, 0x00020000
    s_lshl_b32 s73, s59, 2
    s_lshr_b32 s67, s60, 1
    s_add_u32 s73, s73, s67
    s_lshl_b32 s67, s56, 1
    s_add_u32 s73, s73, s67
    s_lshl_b32 s73, s73, 15
    v_mfma_f32_32x32x16_bf16 v[44:59], v[80:83], v[152:155], v[44:59]
    ds_read_b64_tr_b16 v[76:77], v10 offset:16384
    ds_read_b64_tr_b16 v[78:79], v10 offset:16896
    s_lshl_b32 s67, s58, 11
    s_add_u32 s73, s73, s67
    s_and_b32 s67, s60, 1
    s_lshl_b32 s67, s67, 10
    s_add_u32 s73, s73, s67
    s_waitcnt lgkmcnt(2)
    v_add_f32 v60, v60, v64
    v_add_f32 v68, v68, v72
    v_add_f32 v61, v61, v65
    v_add_f32 v69, v69, v73
    v_add_f32 v62, v62, v66
    v_add_f32 v70, v70, v74
    v_add_f32 v63, v63, v67
    v_add_f32 v71, v71, v75
    v_add_f32 v60, v60, v68
    v_add_f32 v61, v61, v69
    v_add_f32 v62, v62, v70
    v_mfma_f32_32x32x16_bf16 v[44:59], v[84:87], v[156:159], v[44:59]
    ds_read_b64_tr_b16 v[80:81], v11 offset:16384
    ds_read_b64_tr_b16 v[82:83], v11 offset:16896
    v_add_f32 v63, v63, v71
    buffer_store_dwordx4 v[60:63], v23, s[48:51], s73 offen sc1
    v_mfma_f32_32x32x16_bf16 v[44:59], v[88:91], v[160:163], v[44:59]
    v_mfma_f32_16x16x32_bf16 v[24:27], v[88:91], v[16:19], v[24:27]
    ds_read_b64_tr_b16 v[84:85], v8 offset:24576
    ds_read_b64_tr_b16 v[86:87], v8 offset:25088
    v_mfma_f32_32x32x16_bf16 v[44:59], v[92:95], v[164:167], v[44:59]
    ds_read_b64_tr_b16 v[88:89], v9 offset:24576
    ds_read_b64_tr_b16 v[90:91], v9 offset:25088
    s_waitcnt lgkmcnt(6)
    v_mfma_f32_32x32x16_bf16 v[44:59], v[76:79], v[168:171], v[44:59]
    ds_read_b64_tr_b16 v[92:93], v10 offset:24576
    ds_read_b64_tr_b16 v[94:95], v10 offset:25088
    s_waitcnt lgkmcnt(6)
    v_mfma_f32_32x32x16_bf16 v[44:59], v[80:83], v[172:175], v[44:59]
    ds_read_b64_tr_b16 v[76:77], v11 offset:24576
    ds_read_b64_tr_b16 v[78:79], v11 offset:25088
    s_lshl_b32 s74, s59, 3
    s_add_u32 s74, s74, s3
    s_lshl_b32 s74, s74, 8
    s_add_u32 s74, s74, 0x10000
    s_lshl_b32 s70, s58, 3
    s_add_u32 s70, s70, s74
    s_waitcnt vmcnt(0)
    s_mov_b64 exec, 1
    buffer_store_dwordx2 v[20:21], off, s[52:55], s70 offset:0 sc1
    s_mov_b64 exec, -1
    s_waitcnt lgkmcnt(6)
    v_mfma_f32_32x32x16_bf16 v[44:59], v[84:87], v[176:179], v[44:59]
    v_mfma_f32_16x16x32_bf16 v[24:27], v[84:87], v[16:19], v[24:27]
    ds_read_b64_tr_b16 v[80:81], v8 offset:32768
    ds_read_b64_tr_b16 v[82:83], v8 offset:33280
    s_waitcnt lgkmcnt(6)
    v_mfma_f32_32x32x16_bf16 v[44:59], v[88:91], v[180:183], v[44:59]
    ds_read_b64_tr_b16 v[84:85], v9 offset:32768
    ds_read_b64_tr_b16 v[86:87], v9 offset:33280
    s_waitcnt lgkmcnt(6)
    v_mfma_f32_32x32x16_bf16 v[44:59], v[92:95], v[184:187], v[44:59]
    ds_read_b64_tr_b16 v[88:89], v10 offset:32768
    ds_read_b64_tr_b16 v[90:91], v10 offset:33280
    s_waitcnt lgkmcnt(6)
    v_mfma_f32_32x32x16_bf16 v[44:59], v[76:79], v[188:191], v[44:59]
    ds_read_b64_tr_b16 v[92:93], v11 offset:32768
    ds_read_b64_tr_b16 v[94:95], v11 offset:33280
    s_waitcnt lgkmcnt(6)
    v_mfma_f32_32x32x16_bf16 v[44:59], v[80:83], v[192:195], v[44:59]
    v_mfma_f32_16x16x32_bf16 v[24:27], v[80:83], v[16:19], v[24:27]
    ds_read_b64_tr_b16 v[76:77], v8 offset:40960
    ds_read_b64_tr_b16 v[78:79], v8 offset:41472
    s_waitcnt lgkmcnt(6)
    v_mfma_f32_32x32x16_bf16 v[44:59], v[84:87], v[196:199], v[44:59]
    ds_read_b64_tr_b16 v[80:81], v9 offset:40960
    ds_read_b64_tr_b16 v[82:83], v9 offset:41472
    s_waitcnt lgkmcnt(6)
    v_mfma_f32_32x32x16_bf16 v[44:59], v[88:91], v[200:203], v[44:59]
    ds_read_b64_tr_b16 v[84:85], v10 offset:40960
    ds_read_b64_tr_b16 v[86:87], v10 offset:41472
    s_add_u32 m0, s17, 98304
    s_nop 0
    buffer_load_dwordx4 v2, s[12:15], s26 offen lds
    s_waitcnt lgkmcnt(6)
    v_mfma_f32_32x32x16_bf16 v[44:59], v[92:95], v[204:207], v[44:59]
    ds_read_b64_tr_b16 v[88:89], v11 offset:40960
    ds_read_b64_tr_b16 v[90:91], v11 offset:41472
    s_waitcnt lgkmcnt(6)
    v_mfma_f32_32x32x16_bf16 v[44:59], v[76:79], v[208:211], v[44:59]
    v_mfma_f32_16x16x32_bf16 v[24:27], v[76:79], v[16:19], v[24:27]
    ds_read_b64_tr_b16 v[92:93], v8 offset:49152
    ds_read_b64_tr_b16 v[94:95], v8 offset:49664
    s_add_u32 m0, s17, 99328
    s_add_u32 s70, s26, 8192
    buffer_load_dwordx4 v2, s[12:15], s70 offen lds
    s_add_u32 s26, s26, 16384
    s_cmp_eq_u32 s26, 229376
    s_cselect_b32 s26, 0, s26
    s_waitcnt lgkmcnt(6)
    v_mfma_f32_32x32x16_bf16 v[44:59], v[80:83], v[212:215], v[44:59]
    ds_read_b64_tr_b16 v[76:77], v9 offset:49152
    ds_read_b64_tr_b16 v[78:79], v9 offset:49664
    s_waitcnt lgkmcnt(6)
    v_mfma_f32_32x32x16_bf16 v[44:59], v[84:87], v[216:219], v[44:59]
    ds_read_b64_tr_b16 v[80:81], v10 offset:49152
    ds_read_b64_tr_b16 v[82:83], v10 offset:49664
    s_add_u32 m0, s17, 114688
    s_nop 0
    buffer_load_dwordx4 v2, s[12:15], s26 offen lds
    s_waitcnt lgkmcnt(6)
    v_mfma_f32_32x32x16_bf16 v[44:59], v[88:91], v[220:223], v[44:59]
    ds_read_b64_tr_b16 v[84:85], v11 offset:49152
    ds_read_b64_tr_b16 v[86:87], v11 offset:49664
    s_waitcnt lgkmcnt(6)
    v_mfma_f32_32x32x16_bf16 v[44:59], v[92:95], v[224:227], v[44:59]
    v_mfma_f32_16x16x32_bf16 v[24:27], v[92:95], v[16:19], v[24:27]
    ds_read_b64_tr_b16 v[88:89], v8 offset:57344
    ds_read_b64_tr_b16 v[90:91], v8 offset:57856
    s_add_u32 m0, s17, 115712
    s_add_u32 s70, s26, 8192
    buffer_load_dwordx4 v2, s[12:15], s70 offen lds
    s_add_u32 s26, s26, 16384
    s_cmp_eq_u32 s26, 229376
    s_cselect_b32 s26, 0, s26
    s_waitcnt lgkmcnt(6)
    v_mfma_f32_32x32x16_bf16 v[44:59], v[76:79], v[228:231], v[44:59]
    ds_read_b64_tr_b16 v[92:93], v9 offset:57344
    ds_read_b64_tr_b16 v[94:95], v9 offset:57856
    s_waitcnt lgkmcnt(6)
    v_mfma_f32_32x32x16_bf16 v[44:59], v[80:83], v[232:235], v[44:59]
    ds_read_b64_tr_b16 v[76:77], v10 offset:57344
    ds_read_b64_tr_b16 v[78:79], v10 offset:57856
    s_add_u32 m0, s17, 131072
    s_nop 0
    buffer_load_dwordx4 v2, s[12:15], s26 offen lds
    s_waitcnt lgkmcnt(6)
    v_mfma_f32_32x32x16_bf16 v[44:59], v[84:87], v[236:239], v[44:59]
    ds_read_b64_tr_b16 v[80:81], v11 offset:57344
    ds_read_b64_tr_b16 v[82:83], v11 offset:57856
    s_waitcnt lgkmcnt(6)
    v_mfma_f32_32x32x16_bf16 v[44:59], v[88:91], v[240:243], v[44:59]
    v_mfma_f32_16x16x32_bf16 v[24:27], v[88:91], v[16:19], v[24:27]
    s_add_u32 m0, s17, 132096
    s_add_u32 s70, s26, 8192
    buffer_load_dwordx4 v2, s[12:15], s70 offen lds
    s_add_u32 s26, s26, 16384
    s_cmp_eq_u32 s26, 229376
    s_cselect_b32 s26, 0, s26
    s_waitcnt lgkmcnt(4)
    v_mfma_f32_32x32x16_bf16 v[44:59], v[92:95], v[244:247], v[44:59]
    s_waitcnt lgkmcnt(2)
    v_mfma_f32_32x32x16_bf16 v[44:59], v[76:79], v[248:251], v[44:59]
    s_waitcnt lgkmcnt(0)
    v_mfma_f32_32x32x16_bf16 v[44:59], v[80:83], v[252:255], v[44:59]
    v_and_b32 v124, 1, v0
    v_lshlrev_b32 v124, 6, v124
    v_lshrrev_b32 v125, 4, v0
    v_lshl_add_u32 v124, v125, 4, v124
    s_lshl_b32 s65, s3, 7
    s_add_u32 s65, s65, 156160
    v_add_u32 v124, s65, v124
    s_nop 1
    ds_write_b128 v124, v[24:27]
    v_and_b32 v63, 15, v0
    v_lshlrev_b32 v62, 3, v63
    buffer_load_dwordx2 v[60:61], v62, s[52:55], s74 offen sc1
    v_lshrrev_b32 v72, 4, v0
    v_lshlrev_b32 v72, 4, v72
    v_lshl_add_u32 v63, v63, 11, v72
    s_mul_i32 s70, s58, 1984
    s_sub_u32 s63, s73, s70
    s_lshr_b32 s70, s63, 15
    s_lshl_b32 s70, s70, 11
    s_and_b32 s62, s63, 0x7ff
    s_add_u32 s62, s62, s70
    s_waitcnt lgkmcnt(0)
    s_barrier
    v_and_b32 v126, 31, v0
    s_lshl_b32 s65, s56, 9
    s_add_u32 s65, s65, 156160
    v_lshl_add_u32 v126, v126, 2, s65
    ds_read_b32 v116, v126 offset:0
    ds_read_b32 v117, v126 offset:128
    ds_read_b32 v118, v126 offset:256
    ds_read_b32 v119, v126 offset:384
    v_cmp_gt_u32 vcc, 32, v0
    s_waitcnt lgkmcnt(0)
    v_add_f32 v116, v116, v117
    v_add_f32 v118, v118, v119
    v_add_f32 v116, v116, v118
    v_cvt_pk_bf16_f32 v32, v116, v116
    v_and_b32 v117, 0xffff0000, v32
    v_sub_f32 v117, v116, v117
    v_cvt_pk_bf16_f32 v33, v117, v117
    s_add_u32 m0, s17, 0
    s_nop 0
    buffer_load_dwordx4 v2, s[12:15], s26 offen lds
    v_cndmask_b32 v32, 0, v32, vcc
    v_cndmask_b32 v33, 0, v33, vcc
    s_nop 1
    v_mfma_f32_32x32x16_bf16 v[44:59], v[32:35], v[28:31], v[44:59]
    s_nop 7
    s_nop 7
    v_mul_f32 v116, v39, v44
    v_mul_f32 v117, v39, v45
    v_mul_f32 v118, v39, v46
    v_mul_f32 v119, v39, v47
    v_mul_f32 v120, v39, v48
    v_mul_f32 v121, v39, v49
    v_mul_f32 v122, v39, v50
    v_mul_f32 v123, v39, v51
    v_fma_f32 v44, v44, v36, v38
    v_fma_f32 v45, v45, v36, v38
    v_fma_f32 v46, v46, v36, v38
    s_add_u32 m0, s17, 1024
    s_add_u32 s70, s26, 8192
    buffer_load_dwordx4 v2, s[12:15], s70 offen lds
    s_add_u32 s26, s26, 16384
    s_cmp_eq_u32 s26, 229376
    s_cselect_b32 s26, 0, s26
    v_fma_f32 v47, v47, v36, v38
    v_fma_f32 v48, v48, v36, v38
    v_fma_f32 v49, v49, v36, v38
    v_fma_f32 v50, v50, v36, v38
    v_fma_f32 v51, v51, v36, v38
    v_exp_f32 v116, v116 clamp
    v_exp_f32 v117, v117 clamp
    v_exp_f32 v118, v118 clamp
    v_exp_f32 v119, v119 clamp
    v_exp_f32 v120, v120 clamp
    v_exp_f32 v121, v121 clamp
    v_exp_f32 v122, v122 clamp
    v_exp_f32 v123, v123 clamp
    v_max_f32 v44, v44, v38
    v_max_f32 v45, v45, v38
    v_max_f32 v46, v46, v38
    v_max_f32 v47, v47, v38
    s_add_u32 m0, s17, 16384
    s_nop 0
    buffer_load_dwordx4 v2, s[12:15], s26 offen lds
    v_max_f32 v48, v48, v38
    v_max_f32 v49, v49, v38
    v_max_f32 v50, v50, v38
    v_max_f32 v51, v51, v38
    v_add_f32 v44, v44, v116
    v_add_f32 v45, v45, v117
    v_add_f32 v46, v46, v118
    v_add_f32 v47, v47, v119
    v_add_f32 v48, v48, v120
    v_add_f32 v49, v49, v121
    v_add_f32 v50, v50, v122
    v_add_f32 v51, v51, v123
    v_cvt_pk_bf16_f32 v24, v44, v45
    v_cvt_pk_bf16_f32 v25, v46, v47
    v_cvt_pk_bf16_f32 v26, v48, v49
    v_cvt_pk_bf16_f32 v27, v50, v51
    s_add_u32 m0, s17, 17408
    s_add_u32 s70, s26, 8192
    buffer_load_dwordx4 v2, s[12:15], s70 offen lds
    s_add_u32 s26, s26, 16384
    s_cmp_eq_u32 s26, 229376
    s_cselect_b32 s26, 0, s26
    s_waitcnt vmcnt(4)
    v_cmp_ne_u64 vcc, v[60:61], v[20:21]
    s_nop 1
    s_cbranch_vccz .Lrf_ok
    s_mov_b32 s75, 32768
.Lrf_lp:
    s_sleep 4
    buffer_load_dwordx2 v[60:61], v62, s[52:55], s74 offen sc1
    s_waitcnt vmcnt(0)
    v_cmp_ne_u64 vcc, v[60:61], v[20:21]
    s_nop 1
    s_cbranch_vccz .Lrf_ok
    s_sub_u32 s75, s75, 1
    s_cmp_lg_u32 s75, 0
    s_cbranch_scc1 .Lrf_lp
.Lrf_ok:
    buffer_load_dwordx4 v[64:67], v63, s[48:51], s63 offen sc1
    v_mul_f32 v116, v39, v52
    v_mul_f32 v117, v39, v53
    v_mul_f32 v118, v39, v54
    v_mul_f32 v119, v39, v55
    v_mul_f32 v120, v39, v56
    v_mul_f32 v121, v39, v57
    v_mul_f32 v122, v39, v58
    v_mul_f32 v123, v39, v59
    v_fma_f32 v52, v52, v36, v38
    v_fma_f32 v53, v53, v36, v38
    v_fma_f32 v54, v54, v36, v38
    s_add_u32 m0, s17, 32768
    s_nop 0
    buffer_load_dwordx4 v2, s[12:15], s26 offen lds
    v_fma_f32 v55, v55, v36, v38
    v_fma_f32 v56, v56, v36, v38
    v_fma_f32 v57, v57, v36, v38
    v_fma_f32 v58, v58, v36, v38
    v_fma_f32 v59, v59, v36, v38
    v_exp_f32 v116, v116 clamp
    v_exp_f32 v117, v117 clamp
    v_exp_f32 v118, v118 clamp
    v_exp_f32 v119, v119 clamp
    v_exp_f32 v120, v120 clamp
    v_exp_f32 v121, v121 clamp
    s_add_u32 m0, s17, 33792
    s_add_u32 s70, s26, 8192
    buffer_load_dwordx4 v2, s[12:15], s70 offen lds
    s_add_u32 s26, s26, 16384
    s_cmp_eq_u32 s26, 229376
    s_cselect_b32 s26, 0, s26
    v_exp_f32 v122, v122 clamp
    v_exp_f32 v123, v123 clamp
    v_max_f32 v52, v52, v38
    v_max_f32 v53, v53, v38
    v_max_f32 v54, v54, v38
    v_max_f32 v55, v55, v38
    v_max_f32 v56, v56, v38
    v_max_f32 v57, v57, v38
    v_max_f32 v58, v58, v38
    v_max_f32 v59, v59, v38
    v_add_f32 v52, v52, v116
    s_add_u32 m0, s17, 49152
    s_nop 0
    buffer_load_dwordx4 v2, s[12:15], s26 offen lds
    v_add_f32 v53, v53, v117
    v_add_f32 v54, v54, v118
    v_add_f32 v55, v55, v119
    v_add_f32 v56, v56, v120
    v_add_f32 v57, v57, v121
    v_add_f32 v58, v58, v122
    v_add_f32 v59, v59, v123
    v_cvt_pk_bf16_f32 v28, v52, v53
    v_cvt_pk_bf16_f32 v29, v54, v55
    v_cvt_pk_bf16_f32 v30, v56, v57
    v_cvt_pk_bf16_f32 v31, v58, v59
    s_add_u32 m0, s17, 50176
    s_add_u32 s70, s26, 8192
    buffer_load_dwordx4 v2, s[12:15], s70 offen lds
    s_add_u32 s26, s26, 16384
    s_cmp_eq_u32 s26, 229376
    s_cselect_b32 s26, 0, s26
    v_mov_b32 v70, v20
    v_mov_b32 v71, v21
    s_add_u32 s40, s24, 10485760
    s_addc_u32 s41, s25, 0
    s_and_b32 s41, s41, 0xffff
    s_mov_b32 s42, 65536
    s_mov_b32 s43, 0x00020000
    s_lshl_b32 s73, s59, 1
    s_add_u32 s73, s73, s56
    s_lshl_b32 s73, s73, 12
    s_waitcnt vmcnt(4)
    v_add_f32_dpp v64, v64, v64 row_ror:8 row_mask:0xf bank_mask:0xf
    v_add_f32_dpp v65, v65, v65 row_ror:8 row_mask:0xf bank_mask:0xf
    v_add_f32_dpp v66, v66, v66 row_ror:8 row_mask:0xf bank_mask:0xf
    v_add_f32_dpp v67, v67, v67 row_ror:8 row_mask:0xf bank_mask:0xf
    v_add_f32_dpp v64, v64, v64 row_ror:4 row_mask:0xf bank_mask:0xf
    v_add_f32_dpp v65, v65, v65 row_ror:4 row_mask:0xf bank_mask:0xf
    v_add_f32_dpp v66, v66, v66 row_ror:4 row_mask:0xf bank_mask:0xf
    v_add_f32_dpp v67, v67, v67 row_ror:4 row_mask:0xf bank_mask:0xf
    v_add_f32_dpp v64, v64, v64 row_ror:2 row_mask:0xf bank_mask:0xf
    v_add_f32_dpp v65, v65, v65 row_ror:2 row_mask:0xf bank_mask:0xf
    v_add_f32_dpp v66, v66, v66 row_ror:2 row_mask:0xf bank_mask:0xf
    v_add_f32_dpp v67, v67, v67 row_ror:2 row_mask:0xf bank_mask:0xf
    v_add_f32_dpp v64, v64, v64 row_ror:1 row_mask:0xf bank_mask:0xf
    v_add_f32_dpp v65, v65, v65 row_ror:1 row_mask:0xf bank_mask:0xf
    v_add_f32_dpp v66, v66, v66 row_ror:1 row_mask:0xf bank_mask:0xf
    v_add_f32_dpp v67, v67, v67 row_ror:1 row_mask:0xf bank_mask:0xf
    v_cvt_pk_bf16_f32 v68, v64, v65
    v_cvt_pk_bf16_f32 v69, v66, v67
    s_mov_b32 exec_lo, 0x00010001
    s_mov_b32 exec_hi, 0x00010001
    buffer_store_dwordx4 v[68:71], v72, s[40:43], s62 offen sc1
    s_mov_b64 exec, -1
    s_mov_b32 s16, s68
    s_waitcnt vmcnt(1)
    s_branch .Lp2
.Lp2:
    s_and_b32 s61, s2, 7
    s_lshl_b32 s61, s61, 2
    s_lshr_b32 s64, s2, 6
    s_add_u32 s61, s61, s64
    s_lshl_b32 s72, s61, 3
    s_add_u32 s72, s72, s3
    s_lshl_b32 s72, s72, 8
    v_and_b32 v15, 7, v0
    v_lshlrev_b32 v16, 3, v15
    v_or_b32 v17, 32, v16
    v_lshlrev_b32 v12, 4, v0
    v_lshrrev_b32 v4, 5, v0
    v_lshlrev_b32 v4, 9, v4
    v_bfe_u32 v5, v0, 2, 2
    v_lshl_add_u32 v4, v5, 7, v4
    v_bfe_u32 v5, v0, 3, 1
    v_lshl_add_u32 v4, v5, 6, v4
    v_bfe_u32 v5, v0, 4, 1
    v_lshl_add_u32 v4, v5, 5, v4
    v_and_b32 v5, 3, v0
    v_lshl_add_u32 v4, v5, 3, v4
    v_add_u32 v4, s17, v4
    v_xor_b32 v5, 64, v4
    v_add_u32 v6, 0x10000, v4
    v_add_u32 v7, 0x10000, v5
    v_add_u32 v8, 0x10000, v6
    v_add_u32 v9, 0x10000, v7
    ds_read_b64_tr_b16 v[176:177], v6 offset:32768
    ds_read_b64_tr_b16 v[178:179], v6 offset:33792
    ds_read_b64_tr_b16 v[180:181], v7 offset:32768
    ds_read_b64_tr_b16 v[182:183], v7 offset:33792
    ds_read_b64_tr_b16 v[184:185], v6 offset:49152
    ds_read_b64_tr_b16 v[186:187], v6 offset:50176
    ds_read_b64_tr_b16 v[188:189], v7 offset:49152
    ds_read_b64_tr_b16 v[190:191], v7 offset:50176
    ds_read_b64_tr_b16 v[192:193], v8 offset:0
    ds_read_b64_tr_b16 v[194:195], v8 offset:1024
    ds_read_b64_tr_b16 v[196:197], v9 offset:0
    ds_read_b64_tr_b16 v[198:199], v9 offset:1024
    ds_read_b64_tr_b16 v[200:201], v4 offset:0
    ds_read_b64_tr_b16 v[202:203], v4 offset:1024
    ds_read_b64_tr_b16 v[204:205], v5 offset:0
    ds_read_b64_tr_b16 v[206:207], v5 offset:1024
    ds_read_b64_tr_b16 v[208:209], v4 offset:16384
    ds_read_b64_tr_b16 v[210:211], v4 offset:17408
    ds_read_b64_tr_b16 v[212:213], v5 offset:16384
    ds_read_b64_tr_b16 v[214:215], v5 offset:17408
    ds_read_b64_tr_b16 v[216:217], v4 offset:32768
    ds_read_b64_tr_b16 v[218:219], v4 offset:33792
    ds_read_b64_tr_b16 v[220:221], v5 offset:32768
    ds_read_b64_tr_b16 v[222:223], v5 offset:33792
    ds_read_b64_tr_b16 v[224:225], v4 offset:49152
    ds_read_b64_tr_b16 v[226:227], v4 offset:50176
    ds_read_b64_tr_b16 v[228:229], v5 offset:49152
    ds_read_b64_tr_b16 v[230:231], v5 offset:50176
    s_bfe_u32 s64, s2, 0x30003
    s_mul_i32 s74, s61, 288
    s_mul_i32 s70, s3, 14
    s_add_u32 s69, s70, s74
    s_lshl_b32 s69, s69, 10
    s_lshl_b32 s68, s3, 2
    s_add_u32 s68, s68, s74
    s_add_u32 s68, s68, 112
    s_lshl_b32 s68, s68, 10
    s_and_b32 s71, s3, 1
    s_lshl_b32 s71, s71, 11
    v_bfe_u32 v18, v0, 3, 1
    v_mul_u32_u24 v18, 0x24000, v18
    v_lshl_add_u32 v18, v15, 7, v18
    s_lshl_b32 s65, s64, 10
    s_add_u32 s65, s65, s71
    s_add_u32 s65, s65, s69
    s_add_u32 s40, s24, 10485760
    s_addc_u32 s41, s25, 0
    s_and_b32 s41, s41, 0xffff
    s_mov_b32 s42, 65536
    s_mov_b32 s43, 0x00020000
    s_waitcnt lgkmcnt(15)
    s_add_u32 m0, s17, 98304
    s_nop 0
    buffer_load_dwordx4 v2, s[12:15], s26 offen lds
    s_add_u32 m0, s17, 99328
    s_add_u32 s70, s26, 8192
    buffer_load_dwordx4 v2, s[12:15], s70 offen lds
    s_add_u32 s26, s26, 16384
    s_cmp_eq_u32 s26, 229376
    s_cselect_b32 s26, 0, s26
    s_add_u32 m0, s17, 114688
    s_nop 0
    buffer_load_dwordx4 v2, s[12:15], s26 offen lds
    s_add_u32 m0, s17, 115712
    s_add_u32 s70, s26, 8192
    buffer_load_dwordx4 v2, s[12:15], s70 offen lds
    s_add_u32 s26, s26, 16384
    s_cmp_eq_u32 s26, 229376
    s_cselect_b32 s26, 0, s26
    s_add_u32 m0, s17, 131072
    s_nop 0
    buffer_load_dwordx4 v2, s[12:15], s26 offen lds
    s_add_u32 m0, s17, 132096
    s_add_u32 s70, s26, 8192
    buffer_load_dwordx4 v2, s[12:15], s70 offen lds
    s_add_u32 s26, s26, 16384
    s_cmp_eq_u32 s26, 229376
    s_cselect_b32 s26, 0, s26
    s_waitcnt lgkmcnt(12)
    s_add_u32 m0, s17, 0
    s_nop 0
    buffer_load_dwordx4 v2, s[12:15], s26 offen lds
    s_add_u32 m0, s17, 1024
    s_add_u32 s70, s26, 8192
    buffer_load_dwordx4 v2, s[12:15], s70 offen lds
    s_add_u32 s26, s26, 16384
    s_cmp_eq_u32 s26, 229376
    s_cselect_b32 s26, 0, s26
    s_cmp_eq_u32 s57, 0
    s_cbranch_scc1 .Lp2_nf
    s_waitcnt vmcnt(8)
    s_mov_b64 exec, 1
    buffer_store_dwordx2 v[20:21], off, s[52:55], s76 offset:0 sc1
    s_mov_b64 exec, -1
.Lp2_nf:
    s_waitcnt lgkmcnt(8)
    s_add_u32 m0, s17, 16384
    s_nop 0
    buffer_load_dwordx4 v2, s[12:15], s26 offen lds
    s_add_u32 m0, s17, 17408
    s_add_u32 s70, s26, 8192
    buffer_load_dwordx4 v2, s[12:15], s70 offen lds
    s_add_u32 s26, s26, 16384
    s_cmp_eq_u32 s26, 229376
    s_cselect_b32 s26, 0, s26
    s_waitcnt lgkmcnt(4)
    s_add_u32 m0, s17, 32768
    s_nop 0
    buffer_load_dwordx4 v2, s[12:15], s26 offen lds
    s_add_u32 m0, s17, 33792
    s_add_u32 s70, s26, 8192
    buffer_load_dwordx4 v2, s[12:15], s70 offen lds
    s_add_u32 s26, s26, 16384
    s_cmp_eq_u32 s26, 229376
    s_cselect_b32 s26, 0, s26
    s_waitcnt lgkmcnt(0)
    s_add_u32 m0, s17, 49152
    s_nop 0
    buffer_load_dwordx4 v2, s[12:15], s26 offen lds
    s_add_u32 m0, s17, 50176
    s_add_u32 s70, s26, 8192
    buffer_load_dwordx4 v2, s[12:15], s70 offen lds
    s_add_u32 s26, s26, 16384
    s_cmp_eq_u32 s26, 229376
    s_cselect_b32 s26, 0, s26
    s_cmp_lg_u32 s57, 0
    s_cbranch_scc1 .Lp2_nk
    buffer_load_dwordx4 v[32:35], v12, s[40:43], s73 offen offset:0 sc1
    buffer_load_dwordx4 v[36:39], v12, s[40:43], s73 offen offset:1024 sc1
    buffer_load_dwordx4 v[40:43], v12, s[40:43], s73 offen offset:2048 sc1
    buffer_load_dwordx4 v[44:47], v12, s[40:43], s73 offen offset:3072 sc1
.Lp2_nk:
    buffer_load_dwordx2 v[22:23], v17, s[52:55], s72 offen offset:64 sc1
    s_setprio 2
    s_mul_i32 s70, s3, 163840
    v_subrev_u32 v3, s70, v2
    v_add_u32 v13, 0x24000, v12
    v_lshrrev_b32 v14, 3, v0
    v_lshlrev_b32 v14, 10, v14
    v_lshlrev_b32 v15, 4, v15
    v_add_u32 v14, v14, v15
    v_add_u32 v10, s69, v12
    v_add_u32 v11, s69, v13
    v_lshrrev_b32 v19, 1, v0
    v_lshlrev_b32 v19, 10, v19
    s_add_u32 s70, s71, 8192
    v_add_u32 v1, s70, v19
    v_subrev_u32 v97, 14336, v1
    v_min_u32 v1, v1, v97
    v_add_u32 v1, s69, v1
    s_sub_u32 s70, s68, 6144
    v_add_u32 v19, s70, v19
    v_cmp_gt_u32 vcc, 12, v0
    v_and_b32 v97, 1, v0
    v_mul_u32_u24 v97, 0x24000, v97
    v_cndmask_b32 v1, v19, v1, vcc
    v_add_u32 v1, v1, v97
    s_lshl_b32 s64, s64, 7
    s_lshl_b32 s63, s61, 16
    s_lshl_b32 s70, s3, 13
    s_add_u32 s63, s63, s70
    s_add_u32 s63, s63, s64
    s_mov_b32 s48, s18
    s_and_b32 s49, s19, 0xffff
    s_mov_b32 s50, 1024
    s_mov_b32 s51, 0x00020000
    s_mov_b32 s8, s20
    s_and_b32 s9, s21, 0xffff
    s_mov_b32 s10, 2097152
    s_mov_b32 s11, 0x00020000
    s_waitcnt vmcnt(9)
    ds_read_b64_tr_b16 v[232:233], v6 offset:32768
    ds_read_b64_tr_b16 v[234:235], v6 offset:33792
    ds_read_b64_tr_b16 v[236:237], v7 offset:32768
    ds_read_b64_tr_b16 v[238:239], v7 offset:33792
    ds_read_b64_tr_b16 v[240:241], v6 offset:49152
    ds_read_b64_tr_b16 v[242:243], v6 offset:50176
    ds_read_b64_tr_b16 v[244:245], v7 offset:49152
    ds_read_b64_tr_b16 v[246:247], v7 offset:50176
    ds_read_b64_tr_b16 v[248:249], v8 offset:0
    ds_read_b64_tr_b16 v[250:251], v8 offset:1024
    ds_read_b64_tr_b16 v[252:253], v9 offset:0
    ds_read_b64_tr_b16 v[254:255], v9 offset:1024
    s_waitcnt lgkmcnt(8)
    s_add_u32 m0, s17, 98304
    s_mov_b32 s70, 0
    buffer_load_dwordx4 v3, s[4:7], s70 offen lds
    s_add_u32 m0, s17, 99328
    s_mov_b32 s70, 8192
    buffer_load_dwordx4 v3, s[4:7], s70 offen lds
    s_waitcnt lgkmcnt(4)
    s_add_u32 m0, s17, 114688
    s_mov_b32 s70, 16384
    buffer_load_dwordx4 v3, s[4:7], s70 offen lds
    s_add_u32 m0, s17, 115712
    s_mov_b32 s70, 24576
    buffer_load_dwordx4 v3, s[4:7], s70 offen lds
    s_waitcnt lgkmcnt(0)
    s_add_u32 m0, s17, 131072
    s_mov_b32 s70, 32768
    buffer_load_dwordx4 v3, s[4:7], s70 offen lds
    s_add_u32 m0, s17, 132096
    s_mov_b32 s70, 40960
    buffer_load_dwordx4 v3, s[4:7], s70 offen lds
    s_setprio 1
    s_waitcnt vmcnt(6)
    v_cmp_ne_u64 vcc, v[22:23], v[20:21]
    s_nop 1
    s_cbranch_vccz .Lf1_ok
    s_mov_b32 s75, 32768
.Lf1_lp:
    s_sleep 2
    buffer_load_dwordx2 v[22:23], v17, s[52:55], s72 offen offset:64 sc1
    s_waitcnt vmcnt(0)
    v_cmp_ne_u64 vcc, v[22:23], v[20:21]
    s_nop 1
    s_cbranch_vccz .Lf1_ok
    s_sub_u32 s75, s75, 1
    s_cmp_lg_u32 s75, 0
    s_cbranch_scc1 .Lf1_lp
.Lf1_ok:
    s_mov_b64 exec, 0xffff
    buffer_load_dword v96, v18, s[36:39], s65 offen
    s_mov_b64 exec, -1
    s_cmp_lg_u32 s57, 0
    s_cbranch_scc1 .Lp2_la
    s_mov_b32 s46, 0
    v_cmp_ne_u64 vcc, v[34:35], v[20:21]
    v_cmp_ne_u64 s[66:67], v[38:39], v[20:21]
    s_or_b64 vcc, vcc, s[66:67]
    v_cmp_ne_u64 s[66:67], v[42:43], v[20:21]
    s_or_b64 vcc, vcc, s[66:67]
    v_cmp_ne_u64 s[66:67], v[46:47], v[20:21]
    s_or_b64 vcc, vcc, s[66:67]
    s_nop 1
    s_cbranch_vccz .Lp2_o
    buffer_load_dwordx4 v[112:115], v10, s[36:39], s71 offen
    buffer_load_dwordx4 v[116:119], v11, s[36:39], s71 offen
    s_add_u32 s71, s71, 1024
    s_cmp_eq_u32 s71, 14336
    s_cselect_b32 s71, 0, s71
    buffer_load_dwordx4 v[120:123], v10, s[36:39], s71 offen
    buffer_load_dwordx4 v[124:127], v11, s[36:39], s71 offen
    s_add_u32 s71, s71, 1024
    s_cmp_eq_u32 s71, 14336
    s_cselect_b32 s71, 0, s71
    buffer_load_dwordx4 v[128:131], v10, s[36:39], s71 offen
    buffer_load_dwordx4 v[132:135], v11, s[36:39], s71 offen
    s_add_u32 s71, s71, 1024
    s_cmp_eq_u32 s71, 14336
    s_cselect_b32 s71, 0, s71
    buffer_load_dwordx4 v[136:139], v10, s[36:39], s71 offen
    buffer_load_dwordx4 v[140:143], v11, s[36:39], s71 offen
    s_add_u32 s71, s71, 1024
    s_cmp_eq_u32 s71, 14336
    s_cselect_b32 s71, 0, s71
    buffer_load_dwordx4 v[144:147], v10, s[36:39], s71 offen
    buffer_load_dwordx4 v[148:151], v11, s[36:39], s71 offen
    s_add_u32 s71, s71, 1024
    s_cmp_eq_u32 s71, 14336
    s_cselect_b32 s71, 0, s71
    buffer_load_dwordx4 v[152:155], v10, s[36:39], s71 offen
    buffer_load_dwordx4 v[156:159], v11, s[36:39], s71 offen
    s_add_u32 s71, s71, 1024
    s_cmp_eq_u32 s71, 14336
    s_cselect_b32 s71, 0, s71
    buffer_load_dwordx4 v[160:163], v10, s[36:39], s71 offen
    buffer_load_dwordx4 v[164:167], v11, s[36:39], s71 offen
    s_add_u32 s71, s71, 1024
    s_cmp_eq_u32 s71, 14336
    s_cselect_b32 s71, 0, s71
    buffer_load_dwordx4 v[168:171], v10, s[36:39], s71 offen
    buffer_load_dwordx4 v[172:175], v11, s[36:39], s71 offen
    s_add_u32 s71, s71, 1024
    s_cmp_eq_u32 s71, 14336
    s_cselect_b32 s71, 0, s71
    s_mov_b32 s46, 1
    buffer_load_dwordx4 v[32:35], v12, s[40:43], s73 offen offset:0 sc1
    buffer_load_dwordx4 v[36:39], v12, s[40:43], s73 offen offset:1024 sc1
    buffer_load_dwordx4 v[40:43], v12, s[40:43], s73 offen offset:2048 sc1
    buffer_load_dwordx4 v[44:47], v12, s[40:43], s73 offen offset:3072 sc1
    s_waitcnt vmcnt(0)
.Lp2_o:
    s_setprio 3
    v_cmp_ne_u64 vcc, v[34:35], v[20:21]
    v_cmp_ne_u64 s[66:67], v[38:39], v[20:21]
    s_or_b64 vcc, vcc, s[66:67]
    v_cmp_ne_u64 s[66:67], v[42:43], v[20:21]
    s_or_b64 vcc, vcc, s[66:67]
    v_cmp_ne_u64 s[66:67], v[46:47], v[20:21]
    s_or_b64 vcc, vcc, s[66:67]
    s_nop 1
    s_cbranch_vccz .Lkv_ok
    s_mov_b32 s75, 32768
.Lkv_lp:
    s_sleep 8
    buffer_load_dwordx4 v[32:35], v12, s[40:43], s73 offen offset:0 sc1
    buffer_load_dwordx4 v[36:39], v12, s[40:43], s73 offen offset:1024 sc1
    buffer_load_dwordx4 v[40:43], v12, s[40:43], s73 offen offset:2048 sc1
    buffer_load_dwordx4 v[44:47], v12, s[40:43], s73 offen offset:3072 sc1
    s_waitcnt vmcnt(0)
    v_cmp_ne_u64 vcc, v[34:35], v[20:21]
    v_cmp_ne_u64 s[66:67], v[38:39], v[20:21]
    s_or_b64 vcc, vcc, s[66:67]
    v_cmp_ne_u64 s[66:67], v[42:43], v[20:21]
    s_or_b64 vcc, vcc, s[66:67]
    v_cmp_ne_u64 s[66:67], v[46:47], v[20:21]
    s_or_b64 vcc, vcc, s[66:67]
    s_nop 1
    s_cbranch_vccz .Lkv_ok
    s_sub_u32 s75, s75, 1
    s_cmp_lg_u32 s75, 0
    s_cbranch_scc1 .Lkv_lp
.Lkv_ok:
    v_mov_b32 v34, v36
    v_mov_b32 v35, v37
    v_mov_b32 v42, v44
    v_mov_b32 v43, v45
    s_nop 1
    v_mfma_f32_32x32x16_bf16 v[48:63], v[32:35], v[24:27], 0
    v_mfma_f32_32x32x16_bf16 v[64:79], v[40:43], v[28:31], 0
    s_nop 7
    s_nop 7
    v_add_f32 v56, 0x358637bd, v56
    v_rcp_f32 v56, v56
    v_add_f32 v64, 0x358637bd, v64
    v_rcp_f32 v64, v64
    v_mul_f32 v48, v48, v56
    v_mul_f32 v49, v49, v56
    v_mul_f32 v50, v50, v56
    v_mul_f32 v51, v51, v56
    v_mul_f32 v52, v52, v56
    v_mul_f32 v53, v53, v56
    v_mul_f32 v54, v54, v56
    v_mul_f32 v55, v55, v56
    v_cvt_pk_bf16_f32 v24, v48, v49
    v_cvt_pk_bf16_f32 v25, v50, v51
    v_cvt_pk_bf16_f32 v26, v52, v53
    v_cvt_pk_bf16_f32 v27, v54, v55
    buffer_store_dwordx4 v[24:27], v12, s[36:39], s16 offen offset:0 sc1
    v_mul_f32 v72, v72, v64
    v_mul_f32 v73, v73, v64
    v_mul_f32 v74, v74, v64
    v_mul_f32 v75, v75, v64
    v_mul_f32 v76, v76, v64
    v_mul_f32 v77, v77, v64
    v_mul_f32 v78, v78, v64
    v_mul_f32 v79, v79, v64
    v_cvt_pk_bf16_f32 v28, v72, v73
    v_cvt_pk_bf16_f32 v29, v74, v75
    v_cvt_pk_bf16_f32 v30, v76, v77
    v_cvt_pk_bf16_f32 v31, v78, v79
    buffer_store_dwordx4 v[28:31], v12, s[36:39], s16 offen offset:1024 sc1
    s_cmp_eq_u32 s46, 0
    s_cbranch_scc1 .Lp2_la
    s_waitcnt vmcnt(0)
    s_mov_b64 exec, 1
    buffer_store_dwordx2 v[20:21], off, s[52:55], s76 offset:0 sc1
    s_mov_b64 exec, -1
    s_branch .Lp2_ld
.Lp2_la:
    buffer_load_dwordx4 v[112:115], v10, s[36:39], s71 offen
    buffer_load_dwordx4 v[116:119], v11, s[36:39], s71 offen
    s_add_u32 s71, s71, 1024
    s_cmp_eq_u32 s71, 14336
    s_cselect_b32 s71, 0, s71
    buffer_load_dwordx4 v[120:123], v10, s[36:39], s71 offen
    buffer_load_dwordx4 v[124:127], v11, s[36:39], s71 offen
    s_add_u32 s71, s71, 1024
    s_cmp_eq_u32 s71, 14336
    s_cselect_b32 s71, 0, s71
    buffer_load_dwordx4 v[128:131], v10, s[36:39], s71 offen
    buffer_load_dwordx4 v[132:135], v11, s[36:39], s71 offen
    s_add_u32 s71, s71, 1024
    s_cmp_eq_u32 s71, 14336
    s_cselect_b32 s71, 0, s71
    s_cmp_lg_u32 s57, 0
    s_cbranch_scc1 .Lp2_nfa
    s_waitcnt vmcnt(6)
    s_mov_b64 exec, 1
    buffer_store_dwordx2 v[20:21], off, s[52:55], s76 offset:0 sc1
    s_mov_b64 exec, -1
    s_setprio 1
.Lp2_nfa:
    buffer_load_dwordx4 v[136:139], v10, s[36:39], s71 offen
    buffer_load_dwordx4 v[140:143], v11, s[36:39], s71 offen
    s_add_u32 s71, s71, 1024
    s_cmp_eq_u32 s71, 14336
    s_cselect_b32 s71, 0, s71
    buffer_load_dwordx4 v[144:147], v10, s[36:39], s71 offen
    buffer_load_dwordx4 v[148:151], v11, s[36:39], s71 offen
    s_add_u32 s71, s71, 1024
    s_cmp_eq_u32 s71, 14336
    s_cselect_b32 s71, 0, s71
    buffer_load_dwordx4 v[152:155], v10, s[36:39], s71 offen
    buffer_load_dwordx4 v[156:159], v11, s[36:39], s71 offen
    s_add_u32 s71, s71, 1024
    s_cmp_eq_u32 s71, 14336
    s_cselect_b32 s71, 0, s71
    buffer_load_dwordx4 v[160:163], v10, s[36:39], s71 offen
    buffer_load_dwordx4 v[164:167], v11, s[36:39], s71 offen
    s_add_u32 s71, s71, 1024
    s_cmp_eq_u32 s71, 14336
    s_cselect_b32 s71, 0, s71
    buffer_load_dwordx4 v[168:171], v10, s[36:39], s71 offen
    buffer_load_dwordx4 v[172:175], v11, s[36:39], s71 offen
    s_add_u32 s71, s71, 1024
    s_cmp_eq_u32 s71, 14336
    s_cselect_b32 s71, 0, s71
.Lp2_ld:
    s_setprio 1
    buffer_load_dwordx2 v[22:23], v16, s[52:55], s72 offen sc1
    s_waitcnt vmcnt(15)
    v_mfma_f32_32x32x16_bf16 v[32:47], v[176:179], v[112:115], 0
    v_mfma_f32_32x32x16_bf16 v[48:63], v[176:179], v[116:119], 0
    v_mfma_f32_32x32x16_bf16 v[64:79], v[180:183], v[112:115], 0
    v_mfma_f32_32x32x16_bf16 v[80:95], v[180:183], v[116:119], 0
    s_waitcnt vmcnt(13)
    v_mfma_f32_32x32x16_bf16 v[32:47], v[184:187], v[120:123], v[32:47]
    v_mfma_f32_32x32x16_bf16 v[48:63], v[184:187], v[124:127], v[48:63]
    v_mfma_f32_32x32x16_bf16 v[64:79], v[188:191], v[120:123], v[64:79]
    v_mfma_f32_32x32x16_bf16 v[80:95], v[188:191], v[124:127], v[80:95]
    s_waitcnt vmcnt(11)
    v_mfma_f32_32x32x16_bf16 v[32:47], v[192:195], v[128:131], v[32:47]
    v_mfma_f32_32x32x16_bf16 v[48:63], v[192:195], v[132:135], v[48:63]
    v_mfma_f32_32x32x16_bf16 v[64:79], v[196:199], v[128:131], v[64:79]
    v_mfma_f32_32x32x16_bf16 v[80:95], v[196:199], v[132:135], v[80:95]
    s_waitcnt vmcnt(9)
    v_mfma_f32_32x32x16_bf16 v[32:47], v[200:203], v[136:139], v[32:47]
    v_mfma_f32_32x32x16_bf16 v[48:63], v[200:203], v[140:143], v[48:63]
    v_mfma_f32_32x32x16_bf16 v[64:79], v[204:207], v[136:139], v[64:79]
    v_mfma_f32_32x32x16_bf16 v[80:95], v[204:207], v[140:143], v[80:95]
    s_waitcnt vmcnt(7)
    v_mfma_f32_32x32x16_bf16 v[32:47], v[208:211], v[144:147], v[32:47]
    v_mfma_f32_32x32x16_bf16 v[48:63], v[208:211], v[148:151], v[48:63]
    v_mfma_f32_32x32x16_bf16 v[64:79], v[212:215], v[144:147], v[64:79]
    v_mfma_f32_32x32x16_bf16 v[80:95], v[212:215], v[148:151], v[80:95]
    s_waitcnt vmcnt(5)
    v_mfma_f32_32x32x16_bf16 v[32:47], v[216:219], v[152:155], v[32:47]
    v_mfma_f32_32x32x16_bf16 v[48:63], v[216:219], v[156:159], v[48:63]
    v_mfma_f32_32x32x16_bf16 v[64:79], v[220:223], v[152:155], v[64:79]
    v_mfma_f32_32x32x16_bf16 v[80:95], v[220:223], v[156:159], v[80:95]
    s_waitcnt vmcnt(0)
    v_cmp_ne_u64 vcc, v[22:23], v[20:21]
    s_and_b64 vcc, vcc, 0xf0
    s_nop 1
    s_cbranch_vccz .Lf2_ok
    s_mov_b32 s75, 32768
.Lf2_lp:
    s_sleep 6
    buffer_load_dwordx2 v[22:23], v16, s[52:55], s72 offen sc1
    s_waitcnt vmcnt(0)
    v_cmp_ne_u64 vcc, v[22:23], v[20:21]
    s_and_b64 vcc, vcc, 0xf0
    s_nop 1
    s_cbranch_vccz .Lf2_ok
    s_sub_u32 s75, s75, 1
    s_cmp_lg_u32 s75, 0
    s_cbranch_scc1 .Lf2_lp
.Lf2_ok:
    s_mov_b64 exec, 0xfff
    buffer_load_dword v96, v1, s[36:39], s64 offen
    s_mov_b64 exec, -1
    buffer_load_dwordx4 v[176:179], v10, s[36:39], s71 offen
    buffer_load_dwordx4 v[180:183], v11, s[36:39], s71 offen
    s_add_u32 s71, s71, 1024
    s_cmp_eq_u32 s71, 14336
    s_cselect_b32 s71, 0, s71
    buffer_load_dwordx4 v[184:187], v10, s[36:39], s71 offen
    buffer_load_dwordx4 v[188:191], v11, s[36:39], s71 offen
    s_add_u32 s71, s71, 1024
    s_cmp_eq_u32 s71, 14336
    s_cselect_b32 s71, 0, s71
    buffer_load_dwordx4 v[192:195], v10, s[36:39], s71 offen
    buffer_load_dwordx4 v[196:199], v11, s[36:39], s71 offen
    s_add_u32 s71, s71, 1024
    s_cmp_eq_u32 s71, 14336
    s_cselect_b32 s71, 0, s71
    buffer_load_dwordx4 v[200:203], v10, s[36:39], s71 offen
    buffer_load_dwordx4 v[204:207], v11, s[36:39], s71 offen
    s_add_u32 s71, s71, 1024
    s_cmp_eq_u32 s71, 14336
    s_cselect_b32 s71, 0, s71
    buffer_load_dwordx2 v[22:23], v16, s[52:55], s72 offen sc1
    buffer_load_dwordx4 v[208:211], v10, s[36:39], s71 offen
    buffer_load_dwordx4 v[212:215], v11, s[36:39], s71 offen
    s_add_u32 s71, s71, 1024
    s_cmp_eq_u32 s71, 14336
    s_cselect_b32 s71, 0, s71
    buffer_load_dwordx4 v[216:219], v10, s[36:39], s71 offen
    buffer_load_dwordx4 v[220:223], v11, s[36:39], s71 offen
    s_setprio 0
    s_waitcnt vmcnt(16)
    v_mfma_f32_32x32x16_bf16 v[32:47], v[224:227], v[160:163], v[32:47]
    v_mfma_f32_32x32x16_bf16 v[48:63], v[224:227], v[164:167], v[48:63]
    v_mfma_f32_32x32x16_bf16 v[64:79], v[228:231], v[160:163], v[64:79]
    v_mfma_f32_32x32x16_bf16 v[80:95], v[228:231], v[164:167], v[80:95]
    s_waitcnt vmcnt(14)
    v_mfma_f32_32x32x16_bf16 v[32:47], v[232:235], v[168:171], v[32:47]
    v_mfma_f32_32x32x16_bf16 v[48:63], v[232:235], v[172:175], v[48:63]
    v_mfma_f32_32x32x16_bf16 v[64:79], v[236:239], v[168:171], v[64:79]
    v_mfma_f32_32x32x16_bf16 v[80:95], v[236:239], v[172:175], v[80:95]
    s_waitcnt vmcnt(11)
    v_mfma_f32_32x32x16_bf16 v[32:47], v[240:243], v[176:179], v[32:47]
    v_mfma_f32_32x32x16_bf16 v[48:63], v[240:243], v[180:183], v[48:63]
    v_mfma_f32_32x32x16_bf16 v[64:79], v[244:247], v[176:179], v[64:79]
    v_mfma_f32_32x32x16_bf16 v[80:95], v[244:247], v[180:183], v[80:95]
    buffer_load_dwordx4 v[24:27], v14, s[28:31], s63 offen
    buffer_load_dwordx4 v[28:31], v15, s[48:51], s64 offen
    s_waitcnt vmcnt(11)
    ds_read_b64_tr_b16 v[96:97], v4 offset:0
    ds_read_b64_tr_b16 v[98:99], v4 offset:1024
    ds_read_b64_tr_b16 v[100:101], v5 offset:0
    ds_read_b64_tr_b16 v[102:103], v5 offset:1024
    v_mfma_f32_32x32x16_bf16 v[32:47], v[248:251], v[184:187], v[32:47]
    v_mfma_f32_32x32x16_bf16 v[48:63], v[248:251], v[188:191], v[48:63]
    v_mfma_f32_32x32x16_bf16 v[64:79], v[252:255], v[184:187], v[64:79]
    v_mfma_f32_32x32x16_bf16 v[80:95], v[252:255], v[188:191], v[80:95]
    s_waitcnt vmcnt(9)
    ds_read_b64_tr_b16 v[104:105], v4 offset:16384
    ds_read_b64_tr_b16 v[106:107], v4 offset:17408
    ds_read_b64_tr_b16 v[108:109], v5 offset:16384
    ds_read_b64_tr_b16 v[110:111], v5 offset:17408
    s_waitcnt lgkmcnt(4)
    v_mfma_f32_32x32x16_bf16 v[32:47], v[96:99], v[192:195], v[32:47]
    v_mfma_f32_32x32x16_bf16 v[48:63], v[96:99], v[196:199], v[48:63]
    v_mfma_f32_32x32x16_bf16 v[64:79], v[100:103], v[192:195], v[64:79]
    v_mfma_f32_32x32x16_bf16 v[80:95], v[100:103], v[196:199], v[80:95]
    s_add_u32 m0, s17, 0
    s_mov_b32 s70, 49152
    buffer_load_dwordx4 v3, s[4:7], s70 offen lds
    s_add_u32 m0, s17, 1024
    s_mov_b32 s70, 57344
    buffer_load_dwordx4 v3, s[4:7], s70 offen lds
    s_waitcnt vmcnt(9)
    ds_read_b64_tr_b16 v[96:97], v4 offset:32768
    ds_read_b64_tr_b16 v[98:99], v4 offset:33792
    ds_read_b64_tr_b16 v[100:101], v5 offset:32768
    ds_read_b64_tr_b16 v[102:103], v5 offset:33792
    s_waitcnt lgkmcnt(4)
    v_mfma_f32_32x32x16_bf16 v[32:47], v[104:107], v[200:203], v[32:47]
    v_mfma_f32_32x32x16_bf16 v[48:63], v[104:107], v[204:207], v[48:63]
    v_mfma_f32_32x32x16_bf16 v[64:79], v[108:111], v[200:203], v[64:79]
    v_mfma_f32_32x32x16_bf16 v[80:95], v[108:111], v[204:207], v[80:95]
    s_waitcnt vmcnt(8)
    v_cmp_ne_u64 vcc, v[22:23], v[20:21]
    s_and_b64 vcc, vcc, 15
    s_nop 1
    s_cbranch_vccz .Lf3_ok
    s_mov_b32 s75, 32768
.Lf3_lp:
    s_sleep 6
    buffer_load_dwordx2 v[22:23], v16, s[52:55], s72 offen sc1
    s_waitcnt vmcnt(0)
    v_cmp_ne_u64 vcc, v[22:23], v[20:21]
    s_and_b64 vcc, vcc, 15
    s_nop 1
    s_cbranch_vccz .Lf3_ok
    s_sub_u32 s75, s75, 1
    s_cmp_lg_u32 s75, 0
    s_cbranch_scc1 .Lf3_lp
.Lf3_ok:
    buffer_load_dwordx4 v[112:115], v12, s[36:39], s68 offen offset:0
    buffer_load_dwordx4 v[116:119], v13, s[36:39], s68 offen offset:0
    buffer_load_dwordx4 v[120:123], v12, s[36:39], s68 offen offset:1024
    buffer_load_dwordx4 v[124:127], v13, s[36:39], s68 offen offset:1024
    buffer_load_dwordx4 v[128:131], v12, s[36:39], s68 offen offset:2048
    buffer_load_dwordx4 v[132:135], v13, s[36:39], s68 offen offset:2048
    buffer_load_dwordx4 v[136:139], v12, s[36:39], s68 offen offset:3072
    buffer_load_dwordx4 v[140:143], v13, s[36:39], s68 offen offset:3072
    s_waitcnt vmcnt(14)
    ds_read_b64_tr_b16 v[104:105], v4 offset:49152
    ds_read_b64_tr_b16 v[106:107], v4 offset:50176
    ds_read_b64_tr_b16 v[108:109], v5 offset:49152
    ds_read_b64_tr_b16 v[110:111], v5 offset:50176
    s_waitcnt lgkmcnt(4)
    v_mfma_f32_32x32x16_bf16 v[32:47], v[96:99], v[208:211], v[32:47]
    v_mfma_f32_32x32x16_bf16 v[48:63], v[96:99], v[212:215], v[48:63]
    v_mfma_f32_32x32x16_bf16 v[64:79], v[100:103], v[208:211], v[64:79]
    v_mfma_f32_32x32x16_bf16 v[80:95], v[100:103], v[212:215], v[80:95]
    v_bfe_u32 v16, v0, 2, 1
    v_lshlrev_b32 v16, 16, v16
    v_bfe_u32 v18, v0, 1, 1
    v_lshl_add_u32 v16, v18, 14, v16
    v_and_b32 v18, 1, v0
    v_lshl_add_u32 v16, v18, 10, v16
    v_lshrrev_b32 v18, 3, v0
    v_and_b32 v19, 7, v0
    v_xor_b32 v18, v18, v19
    v_lshl_add_u32 v16, v18, 4, v16
    s_lshr_b32 s65, s3, 2
    s_lshl_b32 s65, s65, 15
    s_and_b32 s66, s3, 3
    s_lshl_b32 s66, s66, 7
    s_add_u32 s65, s65, s66
    v_add_u32 v16, s65, v16
    v_add_u32 v18, s17, v12
    v_mov_b32 v19, 159744
    s_mov_b32 s75, 32768
.Lmk:
    ds_read_b128 v[144:147], v19
    s_sub_u32 s75, s75, 1
    s_waitcnt lgkmcnt(0)
    v_min3_u32 v144, v144, v145, v146
    v_min_u32 v144, v144, v147
    v_cmp_eq_u32 vcc, 0, v144
    s_cmp_eq_u32 s75, 0
    s_cbranch_scc1 .Lmk2
    s_cbranch_vccnz .Lmk
.Lmk2:
    v_xor_b32 v148, 0, v18
    v_xor_b32 v149, 16, v18
    v_xor_b32 v150, 32, v18
    v_xor_b32 v151, 48, v18
    v_xor_b32 v152, 65600, v18
    v_xor_b32 v153, 65616, v18
    v_xor_b32 v154, 65632, v18
    v_xor_b32 v155, 65648, v18
    s_waitcnt vmcnt(12)
    ds_read_b64_tr_b16 v[96:97], v6 offset:32768
    ds_read_b64_tr_b16 v[98:99], v6 offset:33792
    ds_read_b64_tr_b16 v[100:101], v7 offset:32768
    ds_read_b64_tr_b16 v[102:103], v7 offset:33792
    v_mfma_f32_32x32x16_bf16 v[32:47], v[104:107], v[216:219], v[32:47]
    v_mfma_f32_32x32x16_bf16 v[48:63], v[104:107], v[220:223], v[48:63]
    v_mfma_f32_32x32x16_bf16 v[64:79], v[108:111], v[216:219], v[64:79]
    v_mfma_f32_32x32x16_bf16 v[80:95], v[108:111], v[220:223], v[80:95]
    s_waitcnt vmcnt(6)
    ds_read_b64_tr_b16 v[104:105], v6 offset:49152
    ds_read_b64_tr_b16 v[106:107], v6 offset:50176
    ds_read_b64_tr_b16 v[108:109], v7 offset:49152
    ds_read_b64_tr_b16 v[110:111], v7 offset:50176
    s_waitcnt lgkmcnt(4)
    v_mfma_f32_32x32x16_bf16 v[32:47], v[96:99], v[112:115], v[32:47]
    v_mfma_f32_32x32x16_bf16 v[48:63], v[96:99], v[116:119], v[48:63]
    v_mfma_f32_32x32x16_bf16 v[64:79], v[100:103], v[112:115], v[64:79]
    v_mfma_f32_32x32x16_bf16 v[80:95], v[100:103], v[116:119], v[80:95]
    s_waitcnt vmcnt(4)
    ds_read_b64_tr_b16 v[96:97], v8 offset:0
    ds_read_b64_tr_b16 v[98:99], v8 offset:1024
    ds_read_b64_tr_b16 v[100:101], v9 offset:0
    ds_read_b64_tr_b16 v[102:103], v9 offset:1024
    s_waitcnt lgkmcnt(4)
    v_mfma_f32_32x32x16_bf16 v[32:47], v[104:107], v[120:123], v[32:47]
    v_mfma_f32_32x32x16_bf16 v[48:63], v[104:107], v[124:127], v[48:63]
    v_mfma_f32_32x32x16_bf16 v[64:79], v[108:111], v[120:123], v[64:79]
    v_mfma_f32_32x32x16_bf16 v[80:95], v[108:111], v[124:127], v[80:95]
    s_waitcnt vmcnt(2)
    ds_read_b64_tr_b16 v[104:105], v4 offset:0
    ds_read_b64_tr_b16 v[106:107], v4 offset:1024
    ds_read_b64_tr_b16 v[108:109], v5 offset:0
    ds_read_b64_tr_b16 v[110:111], v5 offset:1024
    s_waitcnt lgkmcnt(4)
    v_mfma_f32_32x32x16_bf16 v[32:47], v[96:99], v[128:131], v[32:47]
    v_mfma_f32_32x32x16_bf16 v[48:63], v[96:99], v[132:135], v[48:63]
    v_mfma_f32_32x32x16_bf16 v[64:79], v[100:103], v[128:131], v[64:79]
    v_mfma_f32_32x32x16_bf16 v[80:95], v[100:103], v[132:135], v[80:95]
    s_waitcnt vmcnt(0)
    s_waitcnt lgkmcnt(0)
    v_mfma_f32_32x32x16_bf16 v[32:47], v[104:107], v[136:139], v[32:47]
    v_mfma_f32_32x32x16_bf16 v[48:63], v[104:107], v[140:143], v[48:63]
    v_mfma_f32_32x32x16_bf16 v[64:79], v[108:111], v[136:139], v[64:79]
    v_mfma_f32_32x32x16_bf16 v[80:95], v[108:111], v[140:143], v[80:95]
    s_waitcnt vmcnt(10)
    v_lshlrev_b32 v156, 16, v24
    v_and_b32 v157, 0xffff0000, v24
    v_lshlrev_b32 v164, 16, v28
    v_and_b32 v165, 0xffff0000, v28
    v_lshlrev_b32 v158, 16, v25
    v_and_b32 v159, 0xffff0000, v25
    v_lshlrev_b32 v166, 16, v29
    v_and_b32 v167, 0xffff0000, v29
    v_lshlrev_b32 v160, 16, v26
    v_and_b32 v161, 0xffff0000, v26
    v_lshlrev_b32 v168, 16, v30
    v_and_b32 v169, 0xffff0000, v30
    v_lshlrev_b32 v162, 16, v27
    v_and_b32 v163, 0xffff0000, v27
    v_lshlrev_b32 v170, 16, v31
    v_and_b32 v171, 0xffff0000, v31
    ds_write_b128 v148, v[32:35] offset:0
    ds_write_b128 v149, v[36:39] offset:1024
    ds_write_b128 v150, v[40:43] offset:16384
    ds_write_b128 v151, v[44:47] offset:17408
    ds_write_b128 v148, v[48:51] offset:32768
    ds_write_b128 v149, v[52:55] offset:33792
    ds_write_b128 v150, v[56:59] offset:49152
    ds_write_b128 v151, v[60:63] offset:50176
    ds_write_b128 v152, v[64:67] offset:0
    ds_write_b128 v153, v[68:71] offset:1024
    ds_write_b128 v154, v[72:75] offset:16384
    ds_write_b128 v155, v[76:79] offset:17408
    ds_write_b128 v152, v[80:83] offset:32768
    ds_write_b128 v153, v[84:87] offset:33792
    ds_write_b128 v154, v[88:91] offset:49152
    ds_write_b128 v155, v[92:95] offset:50176
    v_add_f32 v156, v156, v164
    v_add_f32 v157, v157, v165
    v_add_f32 v158, v158, v166
    v_add_f32 v159, v159, v167
    v_add_f32 v160, v160, v168
    v_add_f32 v161, v161, v169
    v_add_f32 v162, v162, v170
    v_add_f32 v163, v163, v171
    s_waitcnt lgkmcnt(0)
    s_barrier
    ds_read_b128 v[32:35], v16 offset:0
    ds_read_b128 v[36:39], v16 offset:512
    ds_read_b128 v[40:43], v16 offset:2048
    ds_read_b128 v[44:47], v16 offset:2560
    ds_read_b128 v[48:51], v16 offset:4096
    ds_read_b128 v[52:55], v16 offset:4608
    ds_read_b128 v[56:59], v16 offset:6144
    ds_read_b128 v[60:63], v16 offset:6656
    ds_read_b128 v[64:67], v16 offset:8192
    ds_read_b128 v[68:71], v16 offset:8704
    ds_read_b128 v[72:75], v16 offset:10240
    ds_read_b128 v[76:79], v16 offset:10752
    ds_read_b128 v[80:83], v16 offset:12288
    ds_read_b128 v[84:87], v16 offset:12800
    ds_read_b128 v[88:91], v16 offset:14336
    ds_read_b128 v[92:95], v16 offset:14848
    s_waitcnt lgkmcnt(14)
    v_pk_add_f32 v[156:157], v[156:157], v[32:33]
    v_pk_add_f32 v[158:159], v[158:159], v[34:35]
    v_pk_add_f32 v[160:161], v[160:161], v[36:37]
    v_pk_add_f32 v[162:163], v[162:163], v[38:39]
    s_waitcnt lgkmcnt(12)
    v_pk_add_f32 v[156:157], v[156:157], v[40:41]
    v_pk_add_f32 v[158:159], v[158:159], v[42:43]
    v_pk_add_f32 v[160:161], v[160:161], v[44:45]
    v_pk_add_f32 v[162:163], v[162:163], v[46:47]
    s_waitcnt lgkmcnt(10)
    v_pk_add_f32 v[156:157], v[156:157], v[48:49]
    v_pk_add_f32 v[158:159], v[158:159], v[50:51]
    v_pk_add_f32 v[160:161], v[160:161], v[52:53]
    v_pk_add_f32 v[162:163], v[162:163], v[54:55]
    s_waitcnt lgkmcnt(8)
    v_pk_add_f32 v[156:157], v[156:157], v[56:57]
    v_pk_add_f32 v[158:159], v[158:159], v[58:59]
    v_pk_add_f32 v[160:161], v[160:161], v[60:61]
    v_pk_add_f32 v[162:163], v[162:163], v[62:63]
    s_waitcnt lgkmcnt(6)
    v_pk_add_f32 v[156:157], v[156:157], v[64:65]
    v_pk_add_f32 v[158:159], v[158:159], v[66:67]
    v_pk_add_f32 v[160:161], v[160:161], v[68:69]
    v_pk_add_f32 v[162:163], v[162:163], v[70:71]
    s_waitcnt lgkmcnt(4)
    v_pk_add_f32 v[156:157], v[156:157], v[72:73]
    v_pk_add_f32 v[158:159], v[158:159], v[74:75]
    v_pk_add_f32 v[160:161], v[160:161], v[76:77]
    v_pk_add_f32 v[162:163], v[162:163], v[78:79]
    s_waitcnt lgkmcnt(2)
    v_pk_add_f32 v[156:157], v[156:157], v[80:81]
    v_pk_add_f32 v[158:159], v[158:159], v[82:83]
    v_pk_add_f32 v[160:161], v[160:161], v[84:85]
    v_pk_add_f32 v[162:163], v[162:163], v[86:87]
    s_waitcnt lgkmcnt(0)
    v_pk_add_f32 v[156:157], v[156:157], v[88:89]
    v_pk_add_f32 v[158:159], v[158:159], v[90:91]
    v_pk_add_f32 v[160:161], v[160:161], v[92:93]
    v_pk_add_f32 v[162:163], v[162:163], v[94:95]
    v_cvt_pk_bf16_f32 v164, v156, v157
    v_cvt_pk_bf16_f32 v165, v158, v159
    v_cvt_pk_bf16_f32 v166, v160, v161
    v_cvt_pk_bf16_f32 v167, v162, v163
    buffer_store_dwordx4 v[164:167], v14, s[8:11], s63 offen
.Lp1_end:
    s_endpgm
.section .rodata,"a"
.p2align 6
.amdhsa_kernel parallel_sum__linear_attn_block__dense_activation_gelu__prompt_kernel
  .amdhsa_next_free_vgpr 256
  .amdhsa_next_free_sgpr 102
  .amdhsa_accum_offset 256
  .amdhsa_group_segment_fixed_size 0
  .amdhsa_kernarg_size 88
  .amdhsa_user_sgpr_count 2
  .amdhsa_user_sgpr_kernarg_segment_ptr 1
  .amdhsa_system_sgpr_workgroup_id_x 1
.end_amdhsa_kernel
```
